```python
import torch

def _softmax(x, axis=-1):
    return torch.softmax(x, dim=axis)
def _gelu(x):
    return torch.nn.functional.gelu(x, approximate="tanh")
def _silu(x):
    return torch.nn.functional.silu(x)
def _sigmoid(x):
    return torch.sigmoid(x)
def _layernorm(x, axis=-1, eps=1e-5):
    m = x.mean(dim=axis, keepdim=True)
    v = x.var(dim=axis, keepdim=True, unbiased=False)
    return (x - m) / torch.sqrt(v + eps)
def _scatter_add(tgt, idx, src, axis=0):
    return tgt.clone().index_add_(axis, idx, src)
def _segment_sum(src, seg, n):
    out = torch.zeros((n,) + src.shape[1:], dtype=src.dtype)
    return out.index_add_(0, seg, src)
def _pad(x, pw):
    flat = tuple(v for pair in reversed(pw) for v in pair)
    return torch.nn.functional.pad(x, flat)

kernel_name = 'standalone__mpnn_edge_mlp__graph'

def setup_inputs():

    _w = (lambda a: (lambda t: t.to(torch.bfloat16) if t.is_floating_point() else t)(torch.as_tensor(a)))
    N, deg, D, De = 12500, 64, 64, max(0, 1)
    E = N * deg
    return {
        "x": _w((lambda *s: torch.randn(*s, dtype=torch.bfloat16) * 0.05)(N, D)),
        "e_attr": _w((lambda *s: torch.randn(*s, dtype=torch.bfloat16) * 0.4)(E, De)),
        "src": _w((lambda lo, hi, *s: torch.randint(lo, hi, s))(0, N, E).to(torch.int64)),
        "dst": _w((lambda lo, hi, *s: torch.randint(lo, hi, s))(0, N, E).to(torch.int64)),
        "w_msg": _w((lambda *s: torch.randn(*s, dtype=torch.bfloat16) * 0.4)(2 * D + De, D)),
        "w_upd": _w((lambda *s: torch.randn(*s, dtype=torch.bfloat16) * 0.05)(2 * D, D)),
    }

def reference(x, e_attr, src, dst, w_msg, w_upd):
    N, D = x.shape
    m_in = torch.concatenate([x[src], x[dst], e_attr], axis=-1)
    msg = _silu(m_in @ w_msg)
    agg = _segment_sum(msg, dst, N)
    return _silu(torch.concatenate([x, agg], axis=-1) @ w_upd)
```

```asm
; @launch grid=(256,1,1) block=(1024,1,1) lds=161536
.amdgcn_target "amdgcn-amd-amdhsa--gfx950"
.text
.globl standalone__mpnn_edge_mlp__graph_kernel
.p2align 8
.type standalone__mpnn_edge_mlp__graph_kernel,@function
standalone__mpnn_edge_mlp__graph_kernel:
s_cmp_ge_u32 s2, 256
s_cbranch_scc1 K2_done
s_load_dwordx4 s[40:43], s[0:1], 16
s_load_dwordx2 s[36:37], s[0:1], 8
s_load_dwordx2 s[12:13], s[0:1], 64
s_load_dwordx2 s[8:9], s[0:1], 0
s_load_dwordx4 s[24:27], s[0:1], 32
s_load_dwordx4 s[20:23], s[0:1], 48
v_lshrrev_b32 v2, 6, v0
s_mul_i32 s3, s2, 3136
v_readfirstlane_b32 s28, v2
v_lshl_add_u32 v1, v0, 2, s3
v_and_b32 v6, 63, v0
v_lshlrev_b32 v2, 2, v1
v_lshlrev_b32 v3, 1, v1
v_lshlrev_b32 v6, 4, v6
s_cmp_ge_u32 s28, 13
s_cbranch_scc1 P_aux
s_add_u32 s45, s3, 3136
s_min_u32 s45, s45, 800000
s_waitcnt lgkmcnt(0)
s_mov_b32 s32, s42
s_and_b32 s33, s43, 0xffff
s_mov_b32 s34, 0x30d400
s_mov_b32 s35, 0x20000
buffer_load_dwordx4 v[8:11], v2, s[32:35], 0 offen
s_and_b32 s37, s37, 0xffff
s_mov_b32 s38, 0x186a00
s_mov_b32 s39, 0x20000
s_and_b32 s41, s41, 0xffff
s_mov_b32 s42, 0x30d400
s_mov_b32 s43, 0x20000
s_barrier
buffer_load_dwordx4 v[12:15], v2, s[40:43], 0 offen
buffer_load_dwordx2 v[16:17], v3, s[36:39], 0 offen
v_cmp_gt_u32 s[46:47], s45, v1
s_mov_b32 s16, s12
s_and_b32 s13, s13, 0xffff
s_mov_b32 s14, 0x900000
s_mov_b32 s15, 0x20000
s_or_b32 s17, s13, 0x800000
s_mov_b32 s18, 12500
s_mov_b32 s19, 0x20000
s_and_b32 s9, s9, 0xffff
s_or_b32 s9, s9, 0x800000
s_mov_b32 s10, 12500
s_mov_b32 s11, 0x20000
s_mov_b32 s72, s26
s_and_b32 s73, s27, 0xffff
s_mov_b32 s74, 0x4000
s_mov_b32 s75, 0x20000
s_and_b32 s25, s25, 0xffff
s_mov_b32 s26, 0x4080
s_mov_b32 s27, 0x20000
s_mov_b32 s76, s22
s_and_b32 s77, s23, 0xffff
s_mov_b32 s78, 0x100
s_mov_b32 s79, 0x20000
s_and_b32 s21, s21, 0xffff
s_mov_b32 s22, 0x186a00
s_mov_b32 s23, 0x20000
s_and_b32 s64, s2, 7
s_lshl_b32 s64, s64, 5
s_lshr_b32 s52, s2, 3
s_or_b32 s64, s64, s52
s_lshl_b32 s68, s64, 3
s_add_u32 s68, s68, 0x190000
s_mov_b32 s29, 0
s_mov_b32 s3, 400000
s_mov_b32 s60, 64
s_mov_b32 s4, 272
s_mov_b32 s5, 96000
s_mov_b32 s62, -1
s_mov_b32 s63, 0x1ffff
s_lshl_b32 s52, s28, 12
s_add_u32 s56, s52, 96000
s_add_u32 s57, s56, 1024
s_add_u32 s58, s56, 2048
s_add_u32 s59, s56, 3072
s_and_b32 s61, s28, 3
s_lshl_b32 s61, s61, 5
s_and_b32 s65, s28, 12
s_lshl_b32 s65, s65, 2
s_mov_b32 s45, 0xffff0000
s_setprio 0
v_mov_b32 v4, 1
s_waitcnt vmcnt(2)
v_lshlrev_b32_sdwa v20, 2, v8 dst_sel:DWORD dst_unused:UNUSED_PAD src0_sel:DWORD src1_sel:BYTE_0
v_lshlrev_b32_sdwa v21, 2, v9 dst_sel:DWORD dst_unused:UNUSED_PAD src0_sel:DWORD src1_sel:BYTE_0
v_lshlrev_b32_sdwa v22, 2, v10 dst_sel:DWORD dst_unused:UNUSED_PAD src0_sel:DWORD src1_sel:BYTE_0
v_lshlrev_b32_sdwa v23, 2, v11 dst_sel:DWORD dst_unused:UNUSED_PAD src0_sel:DWORD src1_sel:BYTE_0
s_mov_b64 exec, s[46:47]
ds_add_rtn_u32 v24, v20, v4 offset:19456
ds_add_rtn_u32 v25, v21, v4 offset:19456
ds_add_rtn_u32 v26, v22, v4 offset:19456
ds_add_rtn_u32 v27, v23, v4 offset:19456
s_mov_b64 exec, -1
v_lshrrev_b32 v8, 8, v8
v_lshrrev_b32 v9, 8, v9
v_lshrrev_b32 v10, 8, v10
v_lshrrev_b32 v11, 8, v11
v_mov_b32 v5, 0
s_waitcnt lgkmcnt(0)
s_mov_b64 exec, 1
ds_add_u32 v5, v4 offset:38960
s_mov_b64 exec, -1
v_mul_u32_u24 v44, 0x5556, v24
v_add_u32_sdwa v24, v24, v44 dst_sel:DWORD dst_unused:UNUSED_PAD src0_sel:DWORD src1_sel:WORD_1
v_mad_u32_u16 v44, v44, 12, v24 op_sel:[1,0,0,0]
v_mul_u32_u24 v45, 0x5556, v25
v_add_u32_sdwa v25, v25, v45 dst_sel:DWORD dst_unused:UNUSED_PAD src0_sel:DWORD src1_sel:WORD_1
v_mad_u32_u16 v45, v45, 12, v25 op_sel:[1,0,0,0]
v_mul_u32_u24 v46, 0x5556, v26
v_add_u32_sdwa v26, v26, v46 dst_sel:DWORD dst_unused:UNUSED_PAD src0_sel:DWORD src1_sel:WORD_1
v_mad_u32_u16 v46, v46, 12, v26 op_sel:[1,0,0,0]
v_mul_u32_u24 v47, 0x5556, v27
v_add_u32_sdwa v27, v27, v47 dst_sel:DWORD dst_unused:UNUSED_PAD src0_sel:DWORD src1_sel:WORD_1
v_mad_u32_u16 v47, v47, 12, v27 op_sel:[1,0,0,0]
P_ws:
P_ws_in:
ds_read_b32 v7, v5 offset:38964
s_sub_u32 s3, s3, 1
s_waitcnt lgkmcnt(0)
v_readfirstlane_b32 s52, v7
s_cmp_eq_u32 s52, 1
s_cbranch_scc1 P_ws_ok
s_cmp_gt_i32 s3, 0
s_cbranch_scc1 P_ws
P_ws_ok:
ds_read_b32 v40, v20 offset:20480
ds_read_b32 v41, v21 offset:20480
ds_read_b32 v42, v22 offset:20480
ds_read_b32 v43, v23 offset:20480
s_waitcnt lgkmcnt(3)
v_lshl_add_u32 v24, v24, 2, v40
v_add_u32 v44, v44, v40
s_waitcnt lgkmcnt(2)
v_lshl_add_u32 v25, v25, 2, v41
v_add_u32 v45, v45, v41
s_waitcnt lgkmcnt(1)
v_lshl_add_u32 v26, v26, 2, v42
v_add_u32 v46, v46, v42
s_waitcnt lgkmcnt(0)
v_lshl_add_u32 v27, v27, 2, v43
v_add_u32 v47, v47, v43
s_mov_b64 exec, s[46:47]
ds_write_b8 v44, v8 offset:12
ds_write_b8 v45, v9 offset:12
ds_write_b8 v46, v10 offset:12
ds_write_b8 v47, v11 offset:12
s_waitcnt vmcnt(0)
v_lshl_or_b32 v12, v16, 16, v12
ds_write_b32 v24, v12
v_and_or_b32 v13, v16, s45, v13
ds_write_b32 v25, v13
v_lshl_or_b32 v14, v17, 16, v14
ds_write_b32 v26, v14
v_and_or_b32 v15, v17, s45, v15
ds_write_b32 v27, v15
s_mov_b64 exec, -1
s_branch P_join
P_aux:
v_and_b32 v1, 63, v0
v_mov_b32 v8, 0
v_mov_b32 v9, 0
v_mov_b32 v10, 0
v_mov_b32 v11, 0
ds_write_b128 v6, v[8:11] offset:19456
ds_write_b128 v8, v[8:11] offset:38960
ds_write_b64 v8, v[8:9] offset:38976
s_waitcnt lgkmcnt(0)
s_barrier
s_setprio 3
s_mov_b32 s16, s12
s_and_b32 s13, s13, 0xffff
s_mov_b32 s14, 0x900000
s_mov_b32 s15, 0x20000
s_or_b32 s17, s13, 0x800000
s_mov_b32 s18, 12500
s_mov_b32 s19, 0x20000
s_and_b32 s9, s9, 0xffff
s_or_b32 s9, s9, 0x800000
s_mov_b32 s10, 12500
s_mov_b32 s11, 0x20000
s_mov_b32 s72, s26
s_and_b32 s73, s27, 0xffff
s_mov_b32 s74, 0x4000
s_mov_b32 s75, 0x20000
s_and_b32 s25, s25, 0xffff
s_mov_b32 s26, 0x4080
s_mov_b32 s27, 0x20000
s_mov_b32 s76, s22
s_and_b32 s77, s23, 0xffff
s_mov_b32 s78, 0x100
s_mov_b32 s79, 0x20000
s_and_b32 s21, s21, 0xffff
s_mov_b32 s22, 0x186a00
s_mov_b32 s23, 0x20000
s_and_b32 s64, s2, 7
s_lshl_b32 s64, s64, 5
s_lshr_b32 s52, s2, 3
s_or_b32 s64, s64, s52
s_lshl_b32 s68, s64, 3
s_add_u32 s68, s68, 0x190000
s_mov_b32 s29, 0
s_mov_b32 s3, 400000
s_mov_b32 s60, 64
s_mov_b32 s4, 272
s_mov_b32 s5, 96000
s_mov_b32 s62, -1
s_mov_b32 s63, 0x1ffff
s_lshl_b32 s52, s28, 12
s_add_u32 s56, s52, 96000
s_add_u32 s57, s56, 1024
s_add_u32 s58, s56, 2048
s_add_u32 s59, s56, 3072
s_and_b32 s61, s28, 3
s_lshl_b32 s61, s61, 5
s_and_b32 s65, s28, 12
s_lshl_b32 s65, s65, 2
s_cmp_eq_u32 s28, 15
s_cbranch_scc0 P_p
s_cmp_lg_u32 s2, 0
s_cbranch_scc1 P_nononce
s_memrealtime s[52:53]
s_waitcnt lgkmcnt(0)
s_or_b32 s52, s52, 1
v_mov_b32 v12, s52
s_mov_b64 exec, 1
buffer_store_dword v12, v8, s[76:79], 0 offen sc0 sc1
s_mov_b64 exec, -1
P_nononce:
v_and_b32 v2, 16, v1
v_lshlrev_b32 v2, 1, v2
v_xor_b32 v2, v2, v6
v_xor_b32 v3, 64, v2
s_mov_b32 m0, 96000
s_mov_b32 s52, 8192
s_mov_b32 s53, 12288
P_wc:
P_wc_in:
ds_read_b32 v12, v8 offset:38960
s_sub_u32 s3, s3, 1
s_waitcnt lgkmcnt(0)
v_readfirstlane_b32 s52, v12
s_cmp_eq_u32 s52, 13
s_cbranch_scc1 P_wc_ok
s_cmp_gt_i32 s3, 0
s_cbranch_scc1 P_wc
P_wc_ok:
ds_read_b128 v[28:31], v6 offset:19456
v_mov_b32 v32, 0xaaac
s_mov_b32 s44, 0x5556
s_waitcnt lgkmcnt(0)
v_mad_u32_u24 v44, v28, s44, v32
v_mad_u32_u24 v45, v29, s44, v32
v_mad_u32_u24 v46, v30, s44, v32
v_mad_u32_u24 v47, v31, s44, v32
v_add_u32_sdwa v33, v44, v45 dst_sel:DWORD dst_unused:UNUSED_PAD src0_sel:WORD_1 src1_sel:WORD_1
v_add_u32_sdwa v34, v33, v46 dst_sel:DWORD dst_unused:UNUSED_PAD src0_sel:DWORD src1_sel:WORD_1
v_add_u32_sdwa v36, v34, v47 dst_sel:DWORD dst_unused:UNUSED_PAD src0_sel:DWORD src1_sel:WORD_1
v_lshrrev_b32 v32, 16, v44
v_mov_b32 v35, v36
v_add_u32_dpp v36, v36, v36 row_shr:1 row_mask:0xf bank_mask:0xf bound_ctrl:0
s_nop 1
v_add_u32_dpp v36, v36, v36 row_shr:2 row_mask:0xf bank_mask:0xf bound_ctrl:0
s_nop 1
v_add_u32_dpp v36, v36, v36 row_shr:4 row_mask:0xf bank_mask:0xf bound_ctrl:0
s_nop 1
v_add_u32_dpp v36, v36, v36 row_shr:8 row_mask:0xf bank_mask:0xf bound_ctrl:0
s_nop 1
v_add_u32_dpp v36, v36, v36 row_bcast:15 row_mask:0xa bank_mask:0xf
s_nop 1
v_add_u32_dpp v36, v36, v36 row_bcast:31 row_mask:0xc bank_mask:0xf
v_sub_u32 v35, v36, v35
v_readlane_b32 s55, v36, 63
v_lshlrev_b32 v36, 4, v35
v_add_lshl_u32 v37, v35, v32, 4
v_add_lshl_u32 v38, v35, v33, 4
v_add_lshl_u32 v39, v35, v34, 4
ds_write_b128 v6, v[36:39] offset:20480
v_mov_b32 v13, 1
v_mov_b32 v12, s55
ds_write_b32 v8, v12 offset:38948
ds_write_b32 v8, v13 offset:38964
s_setprio 0
s_mov_b32 s52, 8192
buffer_load_dwordx4 v2, s[24:27], s52 offen offset:0 lds
buffer_load_dwordx4 v3, s[24:27], s52 offen offset:1024 lds
buffer_load_dwordx4 v2, s[24:27], s52 offen offset:2048 lds
buffer_load_dwordx4 v3, s[24:27], s52 offen offset:3072 lds
s_mov_b32 m0, 100096
s_nop 0
buffer_load_dwordx4 v2, s[24:27], s53 offen offset:0 lds
buffer_load_dwordx4 v3, s[24:27], s53 offen offset:1024 lds
buffer_load_dwordx4 v2, s[24:27], s53 offen offset:2048 lds
buffer_load_dwordx4 v3, s[24:27], s53 offen offset:3072 lds
s_mov_b32 m0, 104192
s_mov_b32 s52, 16384
buffer_load_dwordx4 v6, s[24:27], s52 offen lds
P_nspin:
buffer_load_dword v12, v8, s[76:79], 0 offen sc1
s_sub_u32 s3, s3, 1
s_waitcnt vmcnt(0)
v_readfirstlane_b32 s52, v12
s_cmp_lg_u32 s52, 0
s_cbranch_scc1 P_ngot
s_cmp_gt_i32 s3, 0
s_cbranch_scc1 P_nspin
P_ngot:
ds_write_b32 v8, v12 offset:38944
s_mov_b64 exec, 1
ds_add_u32 v8, v13 offset:38980
s_mov_b64 exec, -1
s_mul_i32 s53, s52, 0x9e3779b1
s_and_b32 s53, s53, 0xff000000
v_lshrrev_b32 v36, 4, v36
v_lshl_or_b32 v52, v28, 12, v36
v_or_b32 v52, s53, v52
v_mov_b32 v53, v12
v_lshrrev_b32 v37, 4, v37
v_lshl_or_b32 v54, v29, 12, v37
v_or_b32 v54, s53, v54
v_mov_b32 v55, v12
v_lshrrev_b32 v38, 4, v38
v_lshl_or_b32 v56, v30, 12, v38
v_or_b32 v56, s53, v56
v_mov_b32 v57, v12
v_lshrrev_b32 v39, 4, v39
v_lshl_or_b32 v58, v31, 12, v39
v_or_b32 v58, s53, v58
v_mov_b32 v59, v12
s_branch P_join2
P_p:
s_setprio 3
s_sub_u32 s44, s28, 13
s_lshl_b32 s45, s44, 12
v_and_b32 v2, 16, v1
v_lshlrev_b32 v2, 1, v2
v_xor_b32 v2, v2, v6
s_add_u32 m0, s45, 21504
v_xor_b32 v3, 64, v2
buffer_load_dwordx4 v2, s[24:27], s45 offen offset:0 lds
buffer_load_dwordx4 v3, s[24:27], s45 offen offset:1024 lds
buffer_load_dwordx4 v2, s[24:27], s45 offen offset:2048 lds
buffer_load_dwordx4 v3, s[24:27], s45 offen offset:3072 lds
v_lshrrev_b32 v2, 3, v1
v_xor_b32 v5, v2, v1
v_and_b32 v5, 7, v5
v_lshlrev_b32 v5, 4, v5
s_lshl_b32 s52, s44, 13
s_add_u32 s52, s52, s64
v_lshl_add_u32 v4, v2, 8, s52
s_add_u32 s46, s45, 61312
s_add_u32 m0, s46, 0
s_nop 0
buffer_load_dwordx4 v[4:5], s[8:11], 0 idxen offen lds
s_add_u32 m0, s46, 1024
v_add_u32 v4, 0x800, v4
buffer_load_dwordx4 v[4:5], s[8:11], 0 idxen offen lds
s_add_u32 m0, s46, 2048
v_add_u32 v4, 0x800, v4
buffer_load_dwordx4 v[4:5], s[8:11], 0 idxen offen lds
s_add_u32 m0, s46, 3072
v_add_u32 v4, 0x800, v4
buffer_load_dwordx4 v[4:5], s[8:11], 0 idxen offen lds
v_lshrrev_b32 v11, 5, v1
v_bfe_u32 v7, v1, 2, 2
v_lshl_add_u32 v7, v11, 3, v7
v_lshlrev_b32 v7, 7, v7
v_and_b32 v8, 1, v1
v_xor_b32 v8, v8, v11
v_lshl_add_u32 v7, v8, 6, v7
v_bfe_u32 v8, v1, 1, 1
v_lshl_add_u32 v7, v8, 3, v7
v_and_b32 v8, 16, v1
v_add_u32 v7, v8, v7
v_and_b32 v8, 8, v1
v_lshl_add_u32 v7, v8, 2, v7
v_xor_b32 v2, 32, v7
v_and_b32 v8, 31, v1
v_lshlrev_b32 v8, 7, v8
v_add_u32 v8, s45, v8
v_and_b32 v9, 7, v1
v_xor_b32 v10, v9, v11
v_lshl_add_u32 v40, v10, 4, v8
v_lshlrev_b32 v10, 2, v11
v_xor_b32 v10, v10, v9
v_lshl_add_u32 v44, v10, 4, v8
v_xor_b32 v41, 32, v40
v_xor_b32 v45, 16, v44
v_xor_b32 v42, 64, v40
v_xor_b32 v46, 32, v44
v_xor_b32 v43, 96, v40
v_xor_b32 v47, 48, v44
v_add_u32 v3, s45, v6
v_subrev_u32 v4, 0x1800, v4
s_mov_b32 s46, 0xbfb8aa3b
s_mov_b32 s47, 0xbfb8aa3b
s_lshl_b32 s53, s44, 2
v_mov_b32 v12, s53
v_xor_b32 v13, 4, v12
v_mov_b32 v14, 1
s_waitcnt vmcnt(4)
ds_write_b32 v12, v14 offset:38968
P_ww:
P_ww_in:
ds_read_b32 v15, v13 offset:38968
s_sub_u32 s3, s3, 1
s_waitcnt lgkmcnt(0)
v_readfirstlane_b32 s52, v15
s_cmp_eq_u32 s52, 1
s_cbranch_scc1 P_ww_ok
s_cmp_gt_i32 s3, 0
s_cbranch_scc1 P_ww
P_ww_ok:
s_waitcnt vmcnt(0)
v_mov_b32 v15, 0
s_mov_b64 exec, 1
ds_add_u32 v15, v14 offset:38980
s_mov_b64 exec, -1
ds_read_b128 v[12:15], v40 offset:61312
ds_read_b128 v[16:19], v41 offset:61312
ds_read_b128 v[20:23], v42 offset:61312
ds_read_b128 v[24:27], v43 offset:61312
ds_read_b64_tr_b16 v[48:49], v7 offset:21504
ds_read_b64_tr_b16 v[50:51], v7 offset:22016
ds_read_b64_tr_b16 v[52:53], v7 offset:23552
ds_read_b64_tr_b16 v[54:55], v7 offset:24064
ds_read_b64_tr_b16 v[56:57], v7 offset:25600
ds_read_b64_tr_b16 v[58:59], v7 offset:26112
ds_read_b64_tr_b16 v[60:61], v7 offset:27648
ds_read_b64_tr_b16 v[62:63], v7 offset:28160
ds_read_b64_tr_b16 v[64:65], v2 offset:21504
ds_read_b64_tr_b16 v[66:67], v2 offset:22016
ds_read_b64_tr_b16 v[68:69], v2 offset:23552
ds_read_b64_tr_b16 v[70:71], v2 offset:24064
ds_read_b64_tr_b16 v[72:73], v2 offset:25600
ds_read_b64_tr_b16 v[74:75], v2 offset:26112
ds_read_b64_tr_b16 v[76:77], v2 offset:27648
ds_read_b64_tr_b16 v[78:79], v2 offset:28160
s_waitcnt lgkmcnt(8)
v_mfma_f32_32x32x16_bf16 v[80:95], v[48:51], v[12:15], 0
v_mfma_f32_32x32x16_bf16 v[80:95], v[52:55], v[16:19], v[80:95]
v_mfma_f32_32x32x16_bf16 v[80:95], v[56:59], v[20:23], v[80:95]
v_mfma_f32_32x32x16_bf16 v[80:95], v[60:63], v[24:27], v[80:95]
s_waitcnt lgkmcnt(0)
v_mfma_f32_32x32x16_bf16 v[96:111], v[64:67], v[12:15], 0
v_mfma_f32_32x32x16_bf16 v[96:111], v[68:71], v[16:19], v[96:111]
v_mfma_f32_32x32x16_bf16 v[96:111], v[72:75], v[20:23], v[96:111]
v_mfma_f32_32x32x16_bf16 v[96:111], v[76:79], v[24:27], v[96:111]
s_nop 7
v_pk_mul_f32 v[80:81], v[80:81], s[46:47]
v_pk_mul_f32 v[82:83], v[82:83], s[46:47]
v_pk_mul_f32 v[84:85], v[84:85], s[46:47]
v_pk_mul_f32 v[86:87], v[86:87], s[46:47]
v_pk_mul_f32 v[88:89], v[88:89], s[46:47]
v_pk_mul_f32 v[90:91], v[90:91], s[46:47]
v_pk_mul_f32 v[92:93], v[92:93], s[46:47]
v_pk_mul_f32 v[94:95], v[94:95], s[46:47]
v_cvt_pk_bf16_f32 v48, v80, v81
v_cvt_pk_bf16_f32 v49, v82, v83
v_cvt_pk_bf16_f32 v50, v84, v85
v_cvt_pk_bf16_f32 v51, v86, v87
v_cvt_pk_bf16_f32 v52, v88, v89
v_cvt_pk_bf16_f32 v53, v90, v91
v_cvt_pk_bf16_f32 v54, v92, v93
v_cvt_pk_bf16_f32 v55, v94, v95
ds_write_b128 v44, v[48:51] offset:29696
ds_write_b128 v45, v[52:55] offset:29696
v_pk_mul_f32 v[96:97], v[96:97], s[46:47]
v_pk_mul_f32 v[98:99], v[98:99], s[46:47]
v_pk_mul_f32 v[100:101], v[100:101], s[46:47]
v_pk_mul_f32 v[102:103], v[102:103], s[46:47]
v_pk_mul_f32 v[104:105], v[104:105], s[46:47]
v_pk_mul_f32 v[106:107], v[106:107], s[46:47]
v_pk_mul_f32 v[108:109], v[108:109], s[46:47]
v_pk_mul_f32 v[110:111], v[110:111], s[46:47]
v_cvt_pk_bf16_f32 v56, v96, v97
v_cvt_pk_bf16_f32 v57, v98, v99
v_cvt_pk_bf16_f32 v58, v100, v101
v_cvt_pk_bf16_f32 v59, v102, v103
v_cvt_pk_bf16_f32 v60, v104, v105
v_cvt_pk_bf16_f32 v61, v106, v107
v_cvt_pk_bf16_f32 v62, v108, v109
v_cvt_pk_bf16_f32 v63, v110, v111
ds_write_b128 v46, v[56:59] offset:29696
ds_write_b128 v47, v[60:63] offset:29696
ds_read_b128 v[12:15], v3 offset:29696
ds_read_b128 v[16:19], v3 offset:30720
ds_read_b128 v[20:23], v3 offset:31744
ds_read_b128 v[24:27], v3 offset:32768
s_waitcnt lgkmcnt(3)
buffer_store_dwordx4 v[12:15], v[4:5], s[16:19], 0 idxen offen sc0 sc1
v_add_u32 v4, 0x800, v4
s_waitcnt lgkmcnt(2)
buffer_store_dwordx4 v[16:19], v[4:5], s[16:19], 0 idxen offen sc0 sc1
v_add_u32 v4, 0x800, v4
s_waitcnt lgkmcnt(1)
buffer_store_dwordx4 v[20:23], v[4:5], s[16:19], 0 idxen offen sc0 sc1
v_add_u32 v4, 0x800, v4
s_waitcnt lgkmcnt(0)
buffer_store_dwordx4 v[24:27], v[4:5], s[16:19], 0 idxen offen sc0 sc1
s_setprio 0
s_branch P_join2
P_join:
v_lshlrev_b32 v8, 4, v0
s_mul_i32 s44, s2, 19456
s_add_u32 s44, s44, 0x220000
s_add_u32 s45, s44, 13312
v_add_u32 v21, 832, v0
ds_read_b32 v61, v5 offset:38948
s_waitcnt lgkmcnt(0)
s_mov_b64 exec, 1
ds_add_u32 v5, v4 offset:38976
s_mov_b64 exec, -1
v_cmp_gt_u32 s[32:33], v61, v0
v_cmp_gt_u32 s[34:35], v61, v21
P_wb:
P_wb_in:
ds_read_b32 v7, v5 offset:38976
s_sub_u32 s3, s3, 1
s_waitcnt lgkmcnt(0)
v_readfirstlane_b32 s52, v7
s_cmp_eq_u32 s52, 13
s_cbranch_scc1 P_wb_ok
s_cmp_gt_i32 s3, 0
s_cbranch_scc1 P_wb
P_wb_ok:
ds_read_b128 v[12:15], v8
ds_read_b128 v[16:19], v8 offset:13312
s_mov_b64 exec, s[32:33]
s_waitcnt lgkmcnt(1)
buffer_store_dwordx4 v[12:15], v8, s[12:15], s44 offen sc0 sc1
s_mov_b64 exec, s[34:35]
s_waitcnt lgkmcnt(0)
buffer_store_dwordx4 v[16:19], v8, s[12:15], s45 offen sc0 sc1
s_mov_b64 exec, -1
s_setprio 0
P_join2:
s_lshl_b32 s52, s2, 11
s_add_u32 s52, s52, 0x190000
v_lshl_add_u32 v62, v6, 1, s52
s_mov_b32 s2, 2048
s_mov_b32 s48, 1
K2_restart:
s_mov_b32 s31, 36
s_mov_b32 s30, 0
s_mov_b32 s69, 0x220000
K2_round:
v_mov_b32 v20, 0
v_mov_b32 v21, 0
v_mov_b32 v22, 0
v_mov_b32 v23, 0
v_lshlrev_b32 v8, 4, v0
v_lshrrev_b32 v4, 2, v0
v_lshlrev_b32 v2, 11, v4
s_cmp_lt_u32 s28, 3
s_cbranch_scc0 K2_noz
v_cmp_gt_u32 vcc, 33, v0
s_and_saveexec_b64 s[32:33], vcc
ds_write_b128 v8, v[20:23] offset:38400
s_mov_b64 exec, s[32:33]
K2_noz:
v_and_b32 v1, 63, v0
v_lshlrev_b32 v9, 4, v1
v_and_b32 v10, 31, v1
v_lshrrev_b32 v11, 5, v1
v_bfe_u32 v12, v1, 2, 2
v_xor_b32 v12, v12, v11
v_lshlrev_b32 v12, 4, v12
v_lshl_add_u32 v12, v10, 6, v12
v_add_u32 v120, s56, v12
v_xor_b32 v121, 32, v120
v_and_b32 v12, 2, v10
v_and_b32 v13, 4, v10
v_and_b32 v122, 0x19, v10
v_lshlrev_b32 v122, 3, v122
v_lshl_or_b32 v122, v12, 4, v122
v_lshl_or_b32 v122, v13, 2, v122
v_lshrrev_b32 v14, 2, v1
v_and_b32 v12, 2, v14
v_and_b32 v13, 4, v14
v_and_b32 v123, 0x19, v14
v_lshlrev_b32 v123, 3, v123
v_lshl_or_b32 v123, v12, 4, v123
v_lshl_or_b32 v123, v13, 2, v123
v_lshrrev_b32 v12, 4, v1
v_xor_b32 v12, v12, v1
v_and_b32 v12, 3, v12
v_lshlrev_b32 v117, 4, v12
v_lshlrev_b32 v119, 4, v12
v_mov_b32 v100, 0
v_mov_b32 v102, 1.0
v_mov_b32 v101, 0
v_mov_b32 v103, 1.0
v_mov_b32 v104, 0
v_mov_b32 v106, 1.0
v_mov_b32 v105, 0
v_mov_b32 v107, 1.0
v_mov_b32 v108, 0
v_mov_b32 v109, 0
v_lshlrev_b32 v12, 2, v11
v_sub_u32 v124, 38420, v12
v_mul_u32_u24 v13, 272, v11
v_lshl_add_u32 v125, v10, 2, v13
v_add_u32 v125, 43632, v125
s_waitcnt vmcnt(0) lgkmcnt(0)
s_barrier
s_cmp_eq_u32 s48, 1
s_cbranch_scc0 K2_nosig
s_cmp_eq_u32 s28, 15
s_cbranch_scc0 K2_nosig
buffer_store_dwordx4 v[52:55], v62, s[12:15], 0 offen sc0 sc1
buffer_store_dwordx4 v[56:59], v62, s[12:15], 0 offen offset:16 sc0 sc1
K2_nosig:
ds_read_b32 v60, v20 offset:38944
s_cmp_eq_u32 s28, 1
s_cbranch_scc0 K2_nosel
v_mov_b32 v25, 0x3f803f80
ds_write_b32 v20, v25 offset:38416
K2_nosel:
s_cmp_lg_u32 s30, 0
s_cbranch_scc1 K2_noagg
v_add_u32 v24, 69504, v8
ds_write_b128 v24, v[20:23]
v_cmp_gt_u32 vcc, 626, v0
s_and_saveexec_b64 s[32:33], vcc
ds_write_b128 v24, v[20:23] offset:16384
ds_write_b32 v20, v20 offset:38928
s_mov_b64 exec, s[32:33]
K2_noagg:
s_cmp_eq_u32 s48, 1
s_cbranch_scc0 K2_noq
v_and_b32 v24, 15, v1
v_and_b32 v25, 48, v1
v_add_u32 v26, s65, v24
v_lshlrev_b32 v27, 4, v24
v_and_b32 v27, 0x70, v27
v_xor_b32 v27, v27, v25
v_lshl_add_u32 v5, v26, 7, v27
v_xor_b32 v3, 64, v5
ds_read_b128 v[64:67], v5 offset:61312
ds_read_b128 v[68:71], v3 offset:61312
v_mad_u32_u24 v7, v26, s4, v25
s_lshl_b32 s52, s61, 1
v_add_u32 v7, s52, v7
v_lshrrev_b32 v26, 1, v25
v_bfe_u32 v27, v1, 2, 2
v_add_lshl_u32 v26, v26, v27, 7
v_and_b32 v27, 3, v1
v_lshl_add_u32 v26, v27, 3, v26
v_and_b32 v27, 24, v1
v_lshlrev_b32 v27, 2, v27
v_xor_b32 v27, s61, v27
v_add3_u32 v5, v26, v27, s5
ds_read_b64_tr_b16 v[72:73], v5 offset:0
ds_read_b64_tr_b16 v[74:75], v5 offset:512
ds_read_b64_tr_b16 v[76:77], v5 offset:4096
ds_read_b64_tr_b16 v[78:79], v5 offset:4608
s_mov_b32 s55, 0xbfb8aa3b
s_waitcnt lgkmcnt(0)
v_mfma_f32_16x16x32_bf16 v[24:27], v[72:75], v[64:67], 0
v_mfma_f32_16x16x32_bf16 v[24:27], v[76:79], v[68:71], v[24:27]
s_sub_u32 s52, s28, 0
s_cmp_lt_u32 s52, 2
s_cbranch_scc0 K2_ctdone
s_lshl_b32 s53, s52, 4
v_lshlrev_b32 v12, 3, v11
v_sub_u32 v12, v10, v12
v_subrev_u32 v12, s53, v12
v_mov_b32 v13, 0x3f80
v_mov_b32 v14, 0x3f800000
v_cmp_eq_u32 vcc, 0, v12
v_cmp_eq_u32 s[70:71], 1, v12
s_nop 0
v_cndmask_b32 v16, 0, v13, vcc
v_cndmask_b32 v16, v16, v14, s[70:71]
v_cmp_eq_u32 vcc, 2, v12
v_cmp_eq_u32 s[70:71], 3, v12
s_nop 0
v_cndmask_b32 v17, 0, v13, vcc
v_cndmask_b32 v17, v17, v14, s[70:71]
v_cmp_eq_u32 vcc, 4, v12
v_cmp_eq_u32 s[70:71], 5, v12
s_nop 0
v_cndmask_b32 v18, 0, v13, vcc
v_cndmask_b32 v18, v18, v14, s[70:71]
v_cmp_eq_u32 vcc, 6, v12
v_cmp_eq_u32 s[70:71], 7, v12
s_nop 0
v_cndmask_b32 v19, 0, v13, vcc
v_cndmask_b32 v19, v19, v14, s[70:71]
s_lshl_b32 s52, s52, 10
v_add_u32 v12, s52, v9
ds_write_b128 v12, v[16:19] offset:39040
K2_ctdone:
s_cmp_eq_u32 s28, 2
s_cbranch_scc0 K2_etdone
s_mov_b32 m0, 0
v_and_b32 v12, 15, v1
v_lshrrev_b32 v13, 4, v1
v_lshrrev_b32 v14, 1, v1
v_and_b32 v15, 1, v1
v_lshlrev_b32 v15, 4, v15
v_lshl_add_u32 v14, v14, 7, v15
ds_write_addtid_b32 v14 offset:41600
v_and_b32 v15, 7, v1
v_xor_b32 v15, v15, v13
v_lshlrev_b32 v15, 4, v15
v_lshl_add_u32 v15, v12, 7, v15
ds_write_addtid_b32 v15 offset:41856
v_mul_u32_u24 v16, 528, v13
v_lshl_add_u32 v16, v12, 5, v16
ds_write_addtid_b32 v16 offset:42112
v_mul_u32_u24 v17, 144, v13
v_lshl_add_u32 v17, v12, 3, v17
ds_write_addtid_b32 v17 offset:42368
v_mul_u32_u24 v18, 144, v12
v_lshl_add_u32 v18, v13, 4, v18
ds_write_addtid_b32 v18 offset:42624
v_mul_u32_u24 v19, 144, v12
v_lshl_add_u32 v19, v13, 3, v19
ds_write_addtid_b32 v19 offset:42880
v_lshrrev_b32 v16, 3, v1
v_and_b32 v17, 7, v1
v_lshlrev_b32 v17, 4, v17
v_mul_u32_u24 v18, 144, v16
v_add_u32 v18, v18, v17
ds_write_addtid_b32 v18 offset:43392
v_lshl_add_u32 v17, v16, 15, v17
ds_write_addtid_b32 v17 offset:43648
v_lshrrev_b32 v12, 2, v12
v_lshl_add_u32 v12, v13, 3, v12
v_and_b32 v13, 3, v1
v_lshlrev_b32 v13, 3, v13
v_lshl_add_u32 v12, v12, 5, v13
ds_write_addtid_b32 v12 offset:43136
K2_etdone:
s_cmp_eq_u32 s28, 3
s_cbranch_scc0 K2_w3done
v_lshlrev_b32 v12, 1, v10
v_add_u32 v12, 104192, v12
ds_read_u16 v20, v12
ds_read_u16 v21, v12 offset:64
v_cmp_lt_u32 vcc, 31, v1
v_lshlrev_b32 v14, 3, v1
s_waitcnt lgkmcnt(0)
v_lshlrev_b32 v20, 16, v20
v_mul_f32 v20, s55, v20
v_and_b32 v12, 0xffff0000, v20
v_sub_f32 v13, v20, v12
v_cndmask_b32 v12, v12, v13, vcc
v_cvt_pk_bf16_f32 v20, 0, v12
v_lshlrev_b32 v21, 16, v21
v_mul_f32 v21, s55, v21
v_and_b32 v12, 0xffff0000, v21
v_sub_f32 v13, v21, v12
v_cndmask_b32 v12, v12, v13, vcc
v_cvt_pk_bf16_f32 v21, 0, v12
ds_write_b64 v14, v[20:21] offset:41088
K2_w3done:
s_nop 3
v_mul_f32 v24, s55, v24
v_and_b32 v3, 0xffff0000, v24
v_sub_f32 v24, v24, v3
v_cvt_pk_bf16_f32 v24, v24, v3
v_mul_f32 v25, s55, v25
v_and_b32 v3, 0xffff0000, v25
v_sub_f32 v25, v25, v3
v_cvt_pk_bf16_f32 v25, v25, v3
v_mul_f32 v26, s55, v26
v_and_b32 v3, 0xffff0000, v26
v_sub_f32 v26, v26, v3
v_cvt_pk_bf16_f32 v26, v26, v3
v_mul_f32 v27, s55, v27
v_and_b32 v3, 0xffff0000, v27
v_sub_f32 v27, v27, v3
v_cvt_pk_bf16_f32 v27, v27, v3
ds_write_b128 v7, v[24:27] offset:43904
K2_noq:
s_waitcnt lgkmcnt(0)
v_readfirstlane_b32 s6, v60
s_mul_i32 s7, s6, 0x9e3779b1
s_and_b32 s7, s7, 0xff000000
v_mul_u32_u24 v4, 19456, v4
v_and_b32 v3, 3, v0
v_lshl_add_u32 v4, v3, 4, v4
v_mul_u32_u24 v3, 3, v3
v_mov_b32 v22, 1
v_lshlrev_b32 v12, 2, v1
v_mov_b32 v20, 0x3fff
v_mov_b32 v21, 208
s_and_b32 s52, s64, 31
s_mul_i32 s52, s52, 50048
s_mul_i32 s53, s28, 1152
s_add_u32 s52, s52, s53
v_lshlrev_b32 v23, 7, v1
s_mov_b64 exec, 0x1ff
buffer_load_dword v62, v23, s[12:15], s52 offen sc1
s_mov_b64 exec, -1
s_setprio 3
s_branch K2_poll
K2_again_poll:
K2_poll:
buffer_load_dwordx2 v[42:43], v2, s[12:15], s68 offen sc1
s_sub_u32 s3, s3, 1
s_waitcnt vmcnt(0)
K2_pchk:
v_and_b32 v18, 0xff000000, v42
v_cmp_ne_u32 vcc, s6, v43
v_cmp_ne_u32 s[70:71], s7, v18
s_or_b64 vcc, vcc, s[70:71]
s_cbranch_vccz K2_ready
s_cmp_gt_i32 s3, 0
s_cbranch_scc1 K2_again_poll
K2_ready:
v_bfe_u32 v18, v42, 12, 12
v_subrev_u32 v18, s30, v18
v_min_i32 v19, s31, v18
v_sub_u32 v19, v19, v3
v_and_b32 v16, 0xfff, v42
v_lshl_add_u32 v5, v16, 4, v4
v_cmp_lt_i32 s[32:33], 0, v19
v_cmp_lt_i32 s[38:39], 12, v19
v_cmp_lt_i32 s[44:45], 24, v19
s_mov_b64 exec, s[32:33]
buffer_load_dwordx4 v[24:27], v5, s[12:15], s69 offen offset:0 sc1
s_mov_b64 exec, s[38:39]
buffer_load_dwordx4 v[28:31], v5, s[12:15], s69 offen offset:64 sc1
s_mov_b64 exec, s[44:45]
buffer_load_dwordx4 v[32:35], v5, s[12:15], s69 offen offset:128 sc1
s_mov_b64 exec, -1
v_cmp_lt_i32 s[34:35], 1, v19
v_cmp_lt_i32 s[36:37], 2, v19
v_cmp_lt_i32 s[40:41], 13, v19
v_cmp_lt_i32 s[42:43], 14, v19
v_cmp_lt_i32 s[46:47], 25, v19
v_cmp_lt_i32 s[80:81], 26, v19
v_cmp_lt_i32 s[66:67], s31, v18
s_waitcnt vmcnt(2)
v_mov_b32 v36, v25
v_lshlrev_b32_sdwa v37, 2, v27 dst_sel:DWORD dst_unused:UNUSED_PAD src0_sel:DWORD src1_sel:BYTE_1
v_lshlrev_b32_sdwa v25, 2, v27 dst_sel:DWORD dst_unused:UNUSED_PAD src0_sel:DWORD src1_sel:BYTE_0
v_lshlrev_b32_sdwa v27, 2, v27 dst_sel:DWORD dst_unused:UNUSED_PAD src0_sel:DWORD src1_sel:BYTE_2
s_mov_b64 exec, s[32:33]
ds_add_rtn_u32 v45, v25, v22 offset:38656
s_mov_b64 exec, s[34:35]
ds_add_rtn_u32 v46, v37, v22 offset:38656
s_mov_b64 exec, s[36:37]
ds_add_rtn_u32 v47, v27, v22 offset:38656
s_mov_b64 exec, -1
s_cmp_eq_u64 s[38:39], 0
s_cbranch_scc1 K2_atdone
s_waitcnt vmcnt(1)
v_mov_b32 v38, v29
v_lshlrev_b32_sdwa v39, 2, v31 dst_sel:DWORD dst_unused:UNUSED_PAD src0_sel:DWORD src1_sel:BYTE_1
v_lshlrev_b32_sdwa v29, 2, v31 dst_sel:DWORD dst_unused:UNUSED_PAD src0_sel:DWORD src1_sel:BYTE_0
v_lshlrev_b32_sdwa v31, 2, v31 dst_sel:DWORD dst_unused:UNUSED_PAD src0_sel:DWORD src1_sel:BYTE_2
s_mov_b64 exec, s[38:39]
ds_add_rtn_u32 v48, v29, v22 offset:38656
s_mov_b64 exec, s[40:41]
ds_add_rtn_u32 v49, v39, v22 offset:38656
s_mov_b64 exec, s[42:43]
ds_add_rtn_u32 v50, v31, v22 offset:38656
s_mov_b64 exec, -1
s_cmp_eq_u64 s[44:45], 0
s_cbranch_scc1 K2_atdone
s_waitcnt vmcnt(0)
v_mov_b32 v40, v33
v_lshlrev_b32_sdwa v41, 2, v35 dst_sel:DWORD dst_unused:UNUSED_PAD src0_sel:DWORD src1_sel:BYTE_1
v_lshlrev_b32_sdwa v33, 2, v35 dst_sel:DWORD dst_unused:UNUSED_PAD src0_sel:DWORD src1_sel:BYTE_0
v_lshlrev_b32_sdwa v35, 2, v35 dst_sel:DWORD dst_unused:UNUSED_PAD src0_sel:DWORD src1_sel:BYTE_2
s_mov_b64 exec, s[44:45]
ds_add_rtn_u32 v51, v33, v22 offset:38656
s_mov_b64 exec, s[46:47]
ds_add_rtn_u32 v52, v41, v22 offset:38656
s_mov_b64 exec, s[80:81]
ds_add_rtn_u32 v53, v35, v22 offset:38656
s_mov_b64 exec, -1
K2_atdone:
s_cmp_eq_u64 s[66:67], 0
s_cbranch_scc1 K2_nomore
v_mov_b32 v13, 38912
ds_write_b32 v13, v22
K2_nomore:
s_waitcnt lgkmcnt(0)
s_barrier
ds_read_b32 v13, v12 offset:38656
s_and_b32 s55, s64, 31
s_mul_i32 s55, s55, 50048
v_lshlrev_b32 v23, 7, v0
v_cmp_gt_u32 vcc, 391, v0
s_mov_b64 exec, vcc
buffer_load_dword v2, v23, s[12:15], s55 offen
s_mov_b64 exec, -1
s_waitcnt lgkmcnt(0)
v_add_u32 v14, 3, v13
v_and_b32 v14, -4, v14
v_max_u32 v14, 32, v14
v_cndmask_b32 v14, 0, v14, s[62:63]
v_lshlrev_b32 v15, 3, v14
s_nop 1
v_add_u32_dpp v15, v15, v15 row_shr:1 row_mask:0xf bank_mask:0xf bound_ctrl:0
s_nop 1
v_add_u32_dpp v15, v15, v15 row_shr:2 row_mask:0xf bank_mask:0xf bound_ctrl:0
s_nop 1
v_add_u32_dpp v15, v15, v15 row_shr:4 row_mask:0xf bank_mask:0xf bound_ctrl:0
s_nop 1
v_add_u32_dpp v15, v15, v15 row_shr:8 row_mask:0xf bank_mask:0xf bound_ctrl:0
s_nop 1
v_add_u32_dpp v15, v15, v15 row_bcast:15 row_mask:0xa bank_mask:0xf
s_nop 1
v_add_u32_dpp v15, v15, v15 row_bcast:31 row_mask:0xc bank_mask:0xf
v_lshlrev_b32 v17, 3, v14
v_readlane_b32 s52, v15, 63
v_sub_u32 v15, v15, v17
ds_bpermute_b32 v54, v25, v15
ds_bpermute_b32 v55, v37, v15
ds_bpermute_b32 v56, v27, v15
s_cmp_gt_u32 s52, 38144
s_cbranch_scc1 K2_big
s_cmp_eq_u64 s[38:39], 0
s_cbranch_scc1 K2_bp2
ds_bpermute_b32 v57, v29, v15
ds_bpermute_b32 v58, v39, v15
ds_bpermute_b32 v59, v31, v15
s_cmp_eq_u64 s[44:45], 0
s_cbranch_scc1 K2_bp2
ds_bpermute_b32 v60, v33, v15
ds_bpermute_b32 v61, v41, v15
ds_bpermute_b32 v62, v35, v15
K2_bp2:
s_add_u32 s53, s52, 255
s_and_b32 s54, s53, -256
s_mov_b32 s55, s52
s_lshr_b32 s53, s53, 8
s_lshr_b32 s48, s53, 4
s_and_b32 s53, s53, 15
s_mul_i32 s50, s48, s28
s_min_u32 s52, s28, s53
s_add_u32 s50, s50, s52
s_cmp_lt_u32 s28, s53
s_addc_u32 s48, s48, 0
s_lshl_b32 s52, s50, 8
v_add_u32 v122, s52, v122
v_add_u32 v123, s52, v123
s_lshl_b32 s50, s50, 3
s_mov_b32 s82, 0
v_lshrrev_b32 v127, 5, v15
s_waitcnt lgkmcnt(0)
v_lshl_add_u32 v54, v45, 3, v54
v_lshl_add_u32 v55, v46, 3, v55
v_lshl_add_u32 v56, v47, 3, v56
s_mov_b64 exec, s[32:33]
ds_write_b64 v54, v[24:25]
s_mov_b64 exec, s[34:35]
ds_write_b64 v55, v[36:37]
s_mov_b64 exec, s[36:37]
ds_write_b64 v56, v[26:27]
s_mov_b64 exec, -1
s_cmp_eq_u64 s[38:39], 0
s_cbranch_scc1 K2_scdone
v_lshl_add_u32 v57, v48, 3, v57
v_lshl_add_u32 v58, v49, 3, v58
v_lshl_add_u32 v59, v50, 3, v59
s_mov_b64 exec, s[38:39]
ds_write_b64 v57, v[28:29]
s_mov_b64 exec, s[40:41]
ds_write_b64 v58, v[38:39]
s_mov_b64 exec, s[42:43]
ds_write_b64 v59, v[30:31]
s_mov_b64 exec, -1
s_cmp_eq_u64 s[44:45], 0
s_cbranch_scc1 K2_scdone
v_lshl_add_u32 v60, v51, 3, v60
v_lshl_add_u32 v61, v52, 3, v61
v_lshl_add_u32 v62, v53, 3, v62
s_mov_b64 exec, s[44:45]
ds_write_b64 v60, v[32:33]
s_mov_b64 exec, s[46:47]
ds_write_b64 v61, v[40:41]
s_mov_b64 exec, s[80:81]
ds_write_b64 v62, v[34:35]
s_mov_b64 exec, -1
K2_scdone:
s_cmp_gt_u32 s28, 8
s_cbranch_scc1 K2_nopad
s_cmp_eq_u32 s28, 8
s_cbranch_scc1 K2_tail
v_add_u32 v16, s28, v13
K2_padl:
v_cmp_lt_u32 vcc, v16, v14
v_lshl_add_u32 v17, v16, 3, v15
s_cbranch_vccz K2_nopad
s_mov_b64 exec, vcc
ds_write_b64 v17, v[20:21]
s_mov_b64 exec, -1
v_add_u32 v16, 8, v16
s_branch K2_padl
K2_tail:
v_lshl_add_u32 v16, v1, 3, s55
v_cmp_gt_u32 vcc, s54, v16
s_mov_b64 exec, vcc
ds_write_b64 v16, v[20:21]
s_mov_b64 exec, -1
K2_nopad:
v_cmp_ge_u32 vcc, s50, v127
s_bcnt1_i32_b64 s51, vcc
s_min_u32 s51, s51, 50
s_mul_i32 s52, s51, 528
s_add_u32 s52, s52, 68976
v_lshl_add_u32 v126, v10, 3, s52
v_readlane_b32 s55, v127, s51
s_mov_b32 s54, s50
s_sub_u32 s49, s55, s50
s_waitcnt lgkmcnt(0)
s_barrier
s_cmp_eq_u32 s48, 0
s_cbranch_scc1 K2_notiles
ds_read_u16 v116, v123 offset:0
ds_read_u16 v118, v123 offset:128
ds_read_b64 v[80:81], v122 offset:0
s_waitcnt lgkmcnt(1)
s_mov_b32 m0, s56
s_nop 0
buffer_load_dwordx4 v[116:117], s[16:19], 0 idxen offen lds
s_mov_b32 m0, s57
s_nop 0
buffer_load_dwordx4 v[118:119], s[16:19], 0 idxen offen lds
s_mov_b32 m0, s58
s_nop 0
buffer_load_dwordx4 v[116:117], s[16:19], s60 idxen offen lds
s_mov_b32 m0, s59
s_nop 0
buffer_load_dwordx4 v[118:119], s[16:19], s60 idxen offen lds
ds_read_u16 v116, v123 offset:256
ds_read_u16 v118, v123 offset:384
ds_read_b128 v[92:95], v9 offset:39040
ds_read_b128 v[96:99], v9 offset:40064
v_lshlrev_b32 v12, 3, v1
ds_read_b32 v84, v12 offset:41088
ds_read_b32 v86, v12 offset:41092
s_sub_u32 s48, s48, 1
v_cmp_ge_u32 vcc, s54, v127
s_bcnt1_i32_b64 s52, vcc
s_mul_i32 s53, s52, -4
s_mul_i32 s52, s52, 272
v_add_u32 v111, s52, v125
s_waitcnt lgkmcnt(0)
v_add3_u32 v110, v81, v124, s53
ds_read_b32 v85, v111 offset:0
ds_read_b32 v87, v111 offset:128
ds_read_b32 v81, v110
s_waitcnt vmcnt(0)
ds_read_b128 v[64:67], v120 offset:0
ds_read_b128 v[68:71], v121 offset:0
ds_read_b128 v[72:75], v120 offset:2048
ds_read_b128 v[76:79], v121 offset:2048
ds_read_b64 v[82:83], v122 offset:256
s_waitcnt lgkmcnt(1)
v_mfma_f32_32x32x16_bf16 v[0:15], v[64:67], v[92:95], 0
v_mfma_f32_32x32x16_bf16 v[0:15], v[68:71], v[96:99], v[0:15]
v_mfma_f32_32x32x8_bf16 v[0:15], v[80:81], v[84:85], v[0:15]
v_mfma_f32_32x32x16_bf16 v[16:31], v[72:75], v[92:95], 0
v_mfma_f32_32x32x16_bf16 v[16:31], v[76:79], v[96:99], v[16:31]
v_mfma_f32_32x32x8_bf16 v[16:31], v[80:81], v[86:87], v[16:31]
s_cmp_eq_u32 s48, 0
s_cbranch_scc1 K2_pre2
s_mov_b32 m0, s56
s_nop 0
buffer_load_dwordx4 v[116:117], s[16:19], 0 idxen offen lds
s_mov_b32 m0, s57
s_nop 0
buffer_load_dwordx4 v[118:119], s[16:19], 0 idxen offen lds
s_mov_b32 m0, s58
s_nop 0
buffer_load_dwordx4 v[116:117], s[16:19], s60 idxen offen lds
s_mov_b32 m0, s59
s_nop 0
buffer_load_dwordx4 v[118:119], s[16:19], s60 idxen offen lds
s_add_u32 s54, s50, 8
v_cmp_ge_u32 vcc, s54, v127
s_bcnt1_i32_b64 s52, vcc
s_mul_i32 s53, s52, -4
s_mul_i32 s52, s52, 272
v_add_u32 v111, s52, v125
s_waitcnt lgkmcnt(0)
v_add3_u32 v110, v83, v124, s53
ds_read_b32 v85, v111 offset:0
ds_read_b32 v87, v111 offset:128
ds_read_b32 v83, v110
s_cmp_eq_u32 s29, 0
s_cbranch_scc0 SD0
FD0:
v_exp_f32 v48, v0
v_exp_f32 v49, v1
v_exp_f32 v56, v16
v_exp_f32 v57, v17
v_exp_f32 v50, v2
v_exp_f32 v51, v3
v_exp_f32 v58, v18
v_exp_f32 v59, v19
v_exp_f32 v52, v4
v_exp_f32 v53, v5
v_exp_f32 v60, v20
v_exp_f32 v61, v21
v_exp_f32 v54, v6
v_exp_f32 v55, v7
v_exp_f32 v62, v22
v_exp_f32 v63, v23
s_cmp_lt_u32 s49, 4
s_cbranch_scc1 FD0_C0
v_pk_fma_f32 v[100:101], v[100:101], v[48:49], v[100:101]
v_pk_fma_f32 v[104:105], v[104:105], v[56:57], v[104:105]
v_pk_fma_f32 v[100:101], v[0:1], v[102:103], v[100:101]
v_pk_fma_f32 v[104:105], v[16:17], v[106:107], v[104:105]
v_pk_fma_f32 v[102:103], v[102:103], v[48:49], v[102:103]
v_pk_fma_f32 v[106:107], v[106:107], v[56:57], v[106:107]
v_pk_fma_f32 v[100:101], v[100:101], v[50:51], v[100:101]
v_pk_fma_f32 v[104:105], v[104:105], v[58:59], v[104:105]
v_pk_fma_f32 v[100:101], v[2:3], v[102:103], v[100:101]
v_pk_fma_f32 v[104:105], v[18:19], v[106:107], v[104:105]
v_pk_fma_f32 v[102:103], v[102:103], v[50:51], v[102:103]
v_pk_fma_f32 v[106:107], v[106:107], v[58:59], v[106:107]
v_pk_fma_f32 v[100:101], v[100:101], v[52:53], v[100:101]
v_pk_fma_f32 v[104:105], v[104:105], v[60:61], v[104:105]
v_pk_fma_f32 v[100:101], v[4:5], v[102:103], v[100:101]
v_pk_fma_f32 v[104:105], v[20:21], v[106:107], v[104:105]
v_pk_fma_f32 v[102:103], v[102:103], v[52:53], v[102:103]
v_pk_fma_f32 v[106:107], v[106:107], v[60:61], v[106:107]
v_pk_fma_f32 v[100:101], v[100:101], v[54:55], v[100:101]
v_pk_fma_f32 v[104:105], v[104:105], v[62:63], v[104:105]
v_pk_fma_f32 v[100:101], v[6:7], v[102:103], v[100:101]
v_pk_fma_f32 v[104:105], v[22:23], v[106:107], v[104:105]
v_pk_fma_f32 v[102:103], v[102:103], v[54:55], v[102:103]
v_pk_fma_f32 v[106:107], v[106:107], v[62:63], v[106:107]
FD0_J0:
v_exp_f32 v0, v8
v_exp_f32 v1, v9
v_exp_f32 v16, v24
v_exp_f32 v17, v25
v_exp_f32 v2, v10
v_exp_f32 v3, v11
v_exp_f32 v18, v26
v_exp_f32 v19, v27
v_exp_f32 v4, v12
v_exp_f32 v5, v13
v_exp_f32 v20, v28
v_exp_f32 v21, v29
v_exp_f32 v6, v14
v_exp_f32 v7, v15
v_exp_f32 v22, v30
v_exp_f32 v23, v31
s_cmp_lt_u32 s49, 8
s_cbranch_scc1 FD0_C1
v_pk_fma_f32 v[100:101], v[100:101], v[0:1], v[100:101]
v_pk_fma_f32 v[104:105], v[104:105], v[16:17], v[104:105]
v_pk_fma_f32 v[100:101], v[8:9], v[102:103], v[100:101]
v_pk_fma_f32 v[104:105], v[24:25], v[106:107], v[104:105]
v_pk_fma_f32 v[102:103], v[102:103], v[0:1], v[102:103]
v_pk_fma_f32 v[106:107], v[106:107], v[16:17], v[106:107]
v_pk_fma_f32 v[100:101], v[100:101], v[2:3], v[100:101]
v_pk_fma_f32 v[104:105], v[104:105], v[18:19], v[104:105]
v_pk_fma_f32 v[100:101], v[10:11], v[102:103], v[100:101]
v_pk_fma_f32 v[104:105], v[26:27], v[106:107], v[104:105]
v_pk_fma_f32 v[102:103], v[102:103], v[2:3], v[102:103]
v_pk_fma_f32 v[106:107], v[106:107], v[18:19], v[106:107]
v_pk_fma_f32 v[100:101], v[100:101], v[4:5], v[100:101]
v_pk_fma_f32 v[104:105], v[104:105], v[20:21], v[104:105]
v_pk_fma_f32 v[100:101], v[12:13], v[102:103], v[100:101]
v_pk_fma_f32 v[104:105], v[28:29], v[106:107], v[104:105]
v_pk_fma_f32 v[102:103], v[102:103], v[4:5], v[102:103]
v_pk_fma_f32 v[106:107], v[106:107], v[20:21], v[106:107]
v_pk_fma_f32 v[100:101], v[100:101], v[6:7], v[100:101]
v_pk_fma_f32 v[104:105], v[104:105], v[22:23], v[104:105]
v_pk_fma_f32 v[100:101], v[14:15], v[102:103], v[100:101]
v_pk_fma_f32 v[104:105], v[30:31], v[106:107], v[104:105]
v_pk_fma_f32 v[102:103], v[102:103], v[6:7], v[102:103]
v_pk_fma_f32 v[106:107], v[106:107], v[22:23], v[106:107]
FD0_J1:
s_waitcnt vmcnt(0)
ds_read_b128 v[64:67], v120 offset:0
ds_read_b128 v[68:71], v121 offset:0
ds_read_b128 v[72:75], v120 offset:2048
ds_read_b128 v[76:79], v121 offset:2048
ds_read_u16 v116, v123 offset:512
ds_read_u16 v118, v123 offset:640
ds_read_b64 v[80:81], v122 offset:512
s_add_u32 s50, s50, 8
s_sub_u32 s49, s49, 8
s_sub_u32 s48, s48, 1
s_waitcnt lgkmcnt(1)
v_mfma_f32_32x32x16_bf16 v[32:47], v[64:67], v[92:95], 0
v_mfma_f32_32x32x16_bf16 v[32:47], v[68:71], v[96:99], v[32:47]
v_mfma_f32_32x32x8_bf16 v[32:47], v[82:83], v[84:85], v[32:47]
v_mfma_f32_32x32x16_bf16 v[48:63], v[72:75], v[92:95], 0
v_mfma_f32_32x32x16_bf16 v[48:63], v[76:79], v[96:99], v[48:63]
v_mfma_f32_32x32x8_bf16 v[48:63], v[82:83], v[86:87], v[48:63]
s_cmp_eq_u32 s48, 0
s_cbranch_scc1 FL1n
s_mov_b32 m0, s56
s_nop 0
buffer_load_dwordx4 v[116:117], s[16:19], 0 idxen offen lds
s_mov_b32 m0, s57
s_nop 0
buffer_load_dwordx4 v[118:119], s[16:19], 0 idxen offen lds
s_mov_b32 m0, s58
s_nop 0
buffer_load_dwordx4 v[116:117], s[16:19], s60 idxen offen lds
s_mov_b32 m0, s59
s_nop 0
buffer_load_dwordx4 v[118:119], s[16:19], s60 idxen offen lds
s_add_u32 s54, s50, 8
v_cmp_ge_u32 vcc, s54, v127
s_bcnt1_i32_b64 s52, vcc
s_mul_i32 s53, s52, -4
s_mul_i32 s52, s52, 272
v_add_u32 v111, s52, v125
s_waitcnt lgkmcnt(0)
v_add3_u32 v110, v81, v124, s53
ds_read_b32 v85, v111 offset:0
ds_read_b32 v87, v111 offset:128
ds_read_b32 v81, v110
FE1:
v_exp_f32 v16, v32
v_exp_f32 v17, v33
v_exp_f32 v24, v48
v_exp_f32 v25, v49
v_exp_f32 v18, v34
v_exp_f32 v19, v35
v_exp_f32 v26, v50
v_exp_f32 v27, v51
v_exp_f32 v20, v36
v_exp_f32 v21, v37
v_exp_f32 v28, v52
v_exp_f32 v29, v53
v_exp_f32 v22, v38
v_exp_f32 v23, v39
v_exp_f32 v30, v54
v_exp_f32 v31, v55
s_waitcnt vmcnt(0)
ds_read_b128 v[64:67], v120 offset:0
ds_read_b128 v[68:71], v121 offset:0
ds_read_b128 v[72:75], v120 offset:2048
ds_read_b128 v[76:79], v121 offset:2048
ds_read_u16 v116, v123 offset:768
ds_read_u16 v118, v123 offset:896
s_cmp_lt_u32 s49, 4
s_cbranch_scc1 FE1_C0
v_pk_fma_f32 v[100:101], v[100:101], v[16:17], v[100:101]
v_pk_fma_f32 v[104:105], v[104:105], v[24:25], v[104:105]
v_pk_fma_f32 v[100:101], v[32:33], v[102:103], v[100:101]
v_pk_fma_f32 v[104:105], v[48:49], v[106:107], v[104:105]
v_pk_fma_f32 v[102:103], v[102:103], v[16:17], v[102:103]
v_pk_fma_f32 v[106:107], v[106:107], v[24:25], v[106:107]
v_pk_fma_f32 v[100:101], v[100:101], v[18:19], v[100:101]
v_pk_fma_f32 v[104:105], v[104:105], v[26:27], v[104:105]
v_pk_fma_f32 v[100:101], v[34:35], v[102:103], v[100:101]
v_pk_fma_f32 v[104:105], v[50:51], v[106:107], v[104:105]
v_pk_fma_f32 v[102:103], v[102:103], v[18:19], v[102:103]
v_pk_fma_f32 v[106:107], v[106:107], v[26:27], v[106:107]
v_pk_fma_f32 v[100:101], v[100:101], v[20:21], v[100:101]
v_pk_fma_f32 v[104:105], v[104:105], v[28:29], v[104:105]
v_pk_fma_f32 v[100:101], v[36:37], v[102:103], v[100:101]
v_pk_fma_f32 v[104:105], v[52:53], v[106:107], v[104:105]
v_pk_fma_f32 v[102:103], v[102:103], v[20:21], v[102:103]
v_pk_fma_f32 v[106:107], v[106:107], v[28:29], v[106:107]
v_pk_fma_f32 v[100:101], v[100:101], v[22:23], v[100:101]
v_pk_fma_f32 v[104:105], v[104:105], v[30:31], v[104:105]
v_pk_fma_f32 v[100:101], v[38:39], v[102:103], v[100:101]
v_pk_fma_f32 v[104:105], v[54:55], v[106:107], v[104:105]
v_pk_fma_f32 v[102:103], v[102:103], v[22:23], v[102:103]
v_pk_fma_f32 v[106:107], v[106:107], v[30:31], v[106:107]
FE1_J0:
s_waitcnt lgkmcnt(0)
s_cmp_lt_u32 s48, 2
s_cbranch_scc1 FE1_ng
s_mov_b32 m0, s56
s_nop 0
buffer_load_dwordx4 v[116:117], s[16:19], 0 idxen offen lds
s_mov_b32 m0, s57
s_nop 0
buffer_load_dwordx4 v[118:119], s[16:19], 0 idxen offen lds
s_mov_b32 m0, s58
s_nop 0
buffer_load_dwordx4 v[116:117], s[16:19], s60 idxen offen lds
s_mov_b32 m0, s59
s_nop 0
buffer_load_dwordx4 v[118:119], s[16:19], s60 idxen offen lds
FE1_ng:
ds_read_b64 v[82:83], v122 offset:768
v_mfma_f32_32x32x16_bf16 v[0:15], v[64:67], v[92:95], 0
v_exp_f32 v32, v40
v_exp_f32 v33, v41
v_exp_f32 v48, v56
v_mfma_f32_32x32x16_bf16 v[0:15], v[68:71], v[96:99], v[0:15]
v_exp_f32 v49, v57
v_exp_f32 v34, v42
v_exp_f32 v35, v43
v_mfma_f32_32x32x8_bf16 v[0:15], v[80:81], v[84:85], v[0:15]
v_exp_f32 v50, v58
v_exp_f32 v51, v59
v_exp_f32 v36, v44
v_mfma_f32_32x32x16_bf16 v[16:31], v[72:75], v[92:95], 0
v_exp_f32 v37, v45
v_exp_f32 v52, v60
v_exp_f32 v53, v61
v_mfma_f32_32x32x16_bf16 v[16:31], v[76:79], v[96:99], v[16:31]
v_exp_f32 v38, v46
v_exp_f32 v39, v47
v_exp_f32 v54, v62
v_mfma_f32_32x32x8_bf16 v[16:31], v[80:81], v[86:87], v[16:31]
v_exp_f32 v55, v63
s_waitcnt lgkmcnt(0)
s_cmp_lt_u32 s48, 2
s_cbranch_scc1 FE1_nr
s_add_u32 s54, s50, 16
v_cmp_ge_u32 vcc, s54, v127
s_bcnt1_i32_b64 s52, vcc
s_mul_i32 s53, s52, -4
s_mul_i32 s52, s52, 272
v_add_u32 v111, s52, v125
v_add3_u32 v110, v83, v124, s53
ds_read_b32 v85, v111 offset:0
ds_read_b32 v87, v111 offset:128
ds_read_b32 v83, v110
FE1_nr:
s_cmp_lt_u32 s49, 8
s_cbranch_scc1 FE1_C1
v_pk_fma_f32 v[100:101], v[100:101], v[32:33], v[100:101]
v_pk_fma_f32 v[104:105], v[104:105], v[48:49], v[104:105]
v_pk_fma_f32 v[100:101], v[40:41], v[102:103], v[100:101]
v_pk_fma_f32 v[104:105], v[56:57], v[106:107], v[104:105]
v_pk_fma_f32 v[102:103], v[102:103], v[32:33], v[102:103]
v_pk_fma_f32 v[106:107], v[106:107], v[48:49], v[106:107]
v_pk_fma_f32 v[100:101], v[100:101], v[34:35], v[100:101]
v_pk_fma_f32 v[104:105], v[104:105], v[50:51], v[104:105]
v_pk_fma_f32 v[100:101], v[42:43], v[102:103], v[100:101]
v_pk_fma_f32 v[104:105], v[58:59], v[106:107], v[104:105]
v_pk_fma_f32 v[102:103], v[102:103], v[34:35], v[102:103]
v_pk_fma_f32 v[106:107], v[106:107], v[50:51], v[106:107]
v_pk_fma_f32 v[100:101], v[100:101], v[36:37], v[100:101]
v_pk_fma_f32 v[104:105], v[104:105], v[52:53], v[104:105]
v_pk_fma_f32 v[100:101], v[44:45], v[102:103], v[100:101]
v_pk_fma_f32 v[104:105], v[60:61], v[106:107], v[104:105]
v_pk_fma_f32 v[102:103], v[102:103], v[36:37], v[102:103]
v_pk_fma_f32 v[106:107], v[106:107], v[52:53], v[106:107]
v_pk_fma_f32 v[100:101], v[100:101], v[38:39], v[100:101]
v_pk_fma_f32 v[104:105], v[104:105], v[54:55], v[104:105]
v_pk_fma_f32 v[100:101], v[46:47], v[102:103], v[100:101]
v_pk_fma_f32 v[104:105], v[62:63], v[106:107], v[104:105]
v_pk_fma_f32 v[102:103], v[102:103], v[38:39], v[102:103]
v_pk_fma_f32 v[106:107], v[106:107], v[54:55], v[106:107]
FE1_J1:
s_cmp_lt_u32 s48, 2
s_cbranch_scc1 FE1_nl
s_waitcnt vmcnt(0)
ds_read_b128 v[64:67], v120 offset:0
ds_read_b128 v[68:71], v121 offset:0
ds_read_b128 v[72:75], v120 offset:2048
ds_read_b128 v[76:79], v121 offset:2048
ds_read_u16 v116, v123 offset:1024
ds_read_u16 v118, v123 offset:1152
FE1_nl:
v_add_u32 v122, 512, v122
v_add_u32 v123, 512, v123
s_add_u32 s50, s50, 8
s_sub_u32 s49, s49, 8
s_sub_u32 s48, s48, 1
s_cmp_eq_u32 s48, 0
s_cbranch_scc1 FL0
FM0:
s_cmp_lt_u32 s48, 3
s_cbranch_scc1 FM0_lo
FM0_g:
s_waitcnt lgkmcnt(0)
s_mov_b32 m0, s56
s_nop 0
buffer_load_dwordx4 v[116:117], s[16:19], 0 idxen offen lds
s_mov_b32 m0, s57
s_nop 0
buffer_load_dwordx4 v[118:119], s[16:19], 0 idxen offen lds
s_mov_b32 m0, s58
s_nop 0
buffer_load_dwordx4 v[116:117], s[16:19], s60 idxen offen lds
s_mov_b32 m0, s59
s_nop 0
buffer_load_dwordx4 v[118:119], s[16:19], s60 idxen offen lds
FM0_ng:
v_mfma_f32_32x32x16_bf16 v[32:47], v[64:67], v[92:95], 0
v_exp_f32 v48, v0
v_exp_f32 v49, v1
v_exp_f32 v56, v16
v_exp_f32 v57, v17
v_mfma_f32_32x32x16_bf16 v[32:47], v[68:71], v[96:99], v[32:47]
v_exp_f32 v50, v2
v_exp_f32 v51, v3
v_exp_f32 v58, v18
v_exp_f32 v59, v19
v_mfma_f32_32x32x8_bf16 v[32:47], v[82:83], v[84:85], v[32:47]
v_exp_f32 v52, v4
v_exp_f32 v53, v5
v_exp_f32 v60, v20
v_exp_f32 v61, v21
v_exp_f32 v54, v6
v_exp_f32 v55, v7
v_exp_f32 v62, v22
v_exp_f32 v63, v23
s_cmp_lt_u32 s49, 4
s_cbranch_scc1 FM0_C0
v_pk_fma_f32 v[100:101], v[100:101], v[48:49], v[100:101]
v_pk_fma_f32 v[104:105], v[104:105], v[56:57], v[104:105]
v_pk_fma_f32 v[100:101], v[0:1], v[102:103], v[100:101]
v_pk_fma_f32 v[104:105], v[16:17], v[106:107], v[104:105]
v_pk_fma_f32 v[102:103], v[102:103], v[48:49], v[102:103]
v_pk_fma_f32 v[106:107], v[106:107], v[56:57], v[106:107]
v_pk_fma_f32 v[100:101], v[100:101], v[50:51], v[100:101]
v_pk_fma_f32 v[104:105], v[104:105], v[58:59], v[104:105]
v_pk_fma_f32 v[100:101], v[2:3], v[102:103], v[100:101]
v_pk_fma_f32 v[104:105], v[18:19], v[106:107], v[104:105]
v_pk_fma_f32 v[102:103], v[102:103], v[50:51], v[102:103]
v_pk_fma_f32 v[106:107], v[106:107], v[58:59], v[106:107]
v_pk_fma_f32 v[100:101], v[100:101], v[52:53], v[100:101]
v_pk_fma_f32 v[104:105], v[104:105], v[60:61], v[104:105]
v_pk_fma_f32 v[100:101], v[4:5], v[102:103], v[100:101]
v_pk_fma_f32 v[104:105], v[20:21], v[106:107], v[104:105]
v_pk_fma_f32 v[102:103], v[102:103], v[52:53], v[102:103]
v_pk_fma_f32 v[106:107], v[106:107], v[60:61], v[106:107]
v_pk_fma_f32 v[100:101], v[100:101], v[54:55], v[100:101]
v_pk_fma_f32 v[104:105], v[104:105], v[62:63], v[104:105]
v_pk_fma_f32 v[100:101], v[6:7], v[102:103], v[100:101]
v_pk_fma_f32 v[104:105], v[22:23], v[106:107], v[104:105]
v_pk_fma_f32 v[102:103], v[102:103], v[54:55], v[102:103]
v_pk_fma_f32 v[106:107], v[106:107], v[62:63], v[106:107]
FM0_J0:
ds_read_b64 v[80:81], v122 offset:512
v_mfma_f32_32x32x16_bf16 v[48:63], v[72:75], v[92:95], 0
v_exp_f32 v0, v8
v_exp_f32 v1, v9
v_exp_f32 v16, v24
v_exp_f32 v17, v25
v_mfma_f32_32x32x16_bf16 v[48:63], v[76:79], v[96:99], v[48:63]
v_exp_f32 v2, v10
v_exp_f32 v3, v11
v_exp_f32 v18, v26
v_exp_f32 v19, v27
v_mfma_f32_32x32x8_bf16 v[48:63], v[82:83], v[86:87], v[48:63]
v_exp_f32 v4, v12
v_exp_f32 v5, v13
v_exp_f32 v20, v28
v_exp_f32 v21, v29
v_exp_f32 v6, v14
v_exp_f32 v7, v15
v_exp_f32 v22, v30
v_exp_f32 v23, v31
s_waitcnt lgkmcnt(0)
s_cmp_lt_u32 s48, 2
s_cbranch_scc1 FM0_nr
s_add_u32 s54, s50, 16
v_cmp_ge_u32 vcc, s54, v127
s_bcnt1_i32_b64 s52, vcc
s_mul_i32 s53, s52, -4
s_mul_i32 s52, s52, 272
v_add_u32 v111, s52, v125
v_add3_u32 v110, v81, v124, s53
ds_read_b32 v85, v111 offset:0
ds_read_b32 v87, v111 offset:128
ds_read_b32 v81, v110
FM0_nr:
s_cmp_lt_u32 s49, 8
s_cbranch_scc1 FM0_C1
v_pk_fma_f32 v[100:101], v[100:101], v[0:1], v[100:101]
v_pk_fma_f32 v[104:105], v[104:105], v[16:17], v[104:105]
v_pk_fma_f32 v[100:101], v[8:9], v[102:103], v[100:101]
v_pk_fma_f32 v[104:105], v[24:25], v[106:107], v[104:105]
v_pk_fma_f32 v[102:103], v[102:103], v[0:1], v[102:103]
v_pk_fma_f32 v[106:107], v[106:107], v[16:17], v[106:107]
v_pk_fma_f32 v[100:101], v[100:101], v[2:3], v[100:101]
v_pk_fma_f32 v[104:105], v[104:105], v[18:19], v[104:105]
v_pk_fma_f32 v[100:101], v[10:11], v[102:103], v[100:101]
v_pk_fma_f32 v[104:105], v[26:27], v[106:107], v[104:105]
v_pk_fma_f32 v[102:103], v[102:103], v[2:3], v[102:103]
v_pk_fma_f32 v[106:107], v[106:107], v[18:19], v[106:107]
v_pk_fma_f32 v[100:101], v[100:101], v[4:5], v[100:101]
v_pk_fma_f32 v[104:105], v[104:105], v[20:21], v[104:105]
v_pk_fma_f32 v[100:101], v[12:13], v[102:103], v[100:101]
v_pk_fma_f32 v[104:105], v[28:29], v[106:107], v[104:105]
v_pk_fma_f32 v[102:103], v[102:103], v[4:5], v[102:103]
v_pk_fma_f32 v[106:107], v[106:107], v[20:21], v[106:107]
v_pk_fma_f32 v[100:101], v[100:101], v[6:7], v[100:101]
v_pk_fma_f32 v[104:105], v[104:105], v[22:23], v[104:105]
v_pk_fma_f32 v[100:101], v[14:15], v[102:103], v[100:101]
v_pk_fma_f32 v[104:105], v[30:31], v[106:107], v[104:105]
v_pk_fma_f32 v[102:103], v[102:103], v[6:7], v[102:103]
v_pk_fma_f32 v[106:107], v[106:107], v[22:23], v[106:107]
FM0_J1:
s_cmp_lt_u32 s48, 2
s_cbranch_scc1 FM0_nl
s_waitcnt vmcnt(0)
ds_read_b128 v[64:67], v120 offset:0
ds_read_b128 v[68:71], v121 offset:0
ds_read_b128 v[72:75], v120 offset:2048
ds_read_b128 v[76:79], v121 offset:2048
ds_read_u16 v116, v123 offset:768
ds_read_u16 v118, v123 offset:896
FM0_nl:
s_add_u32 s50, s50, 8
s_sub_u32 s49, s49, 8
s_sub_u32 s48, s48, 1
s_cmp_eq_u32 s48, 0
s_cbranch_scc1 FL1
FM1:
s_cmp_lt_u32 s48, 3
s_cbranch_scc1 FM1_lo
FM1_g:
s_waitcnt lgkmcnt(0)
s_mov_b32 m0, s56
s_nop 0
buffer_load_dwordx4 v[116:117], s[16:19], 0 idxen offen lds
s_mov_b32 m0, s57
s_nop 0
buffer_load_dwordx4 v[118:119], s[16:19], 0 idxen offen lds
s_mov_b32 m0, s58
s_nop 0
buffer_load_dwordx4 v[116:117], s[16:19], s60 idxen offen lds
s_mov_b32 m0, s59
s_nop 0
buffer_load_dwordx4 v[118:119], s[16:19], s60 idxen offen lds
FM1_ng:
v_mfma_f32_32x32x16_bf16 v[0:15], v[64:67], v[92:95], 0
v_exp_f32 v16, v32
v_exp_f32 v17, v33
v_exp_f32 v24, v48
v_exp_f32 v25, v49
v_mfma_f32_32x32x16_bf16 v[0:15], v[68:71], v[96:99], v[0:15]
v_exp_f32 v18, v34
v_exp_f32 v19, v35
v_exp_f32 v26, v50
v_exp_f32 v27, v51
v_mfma_f32_32x32x8_bf16 v[0:15], v[80:81], v[84:85], v[0:15]
v_exp_f32 v20, v36
v_exp_f32 v21, v37
v_exp_f32 v28, v52
v_exp_f32 v29, v53
v_exp_f32 v22, v38
v_exp_f32 v23, v39
v_exp_f32 v30, v54
v_exp_f32 v31, v55
s_cmp_lt_u32 s49, 4
s_cbranch_scc1 FM1_C0
v_pk_fma_f32 v[100:101], v[100:101], v[16:17], v[100:101]
v_pk_fma_f32 v[104:105], v[104:105], v[24:25], v[104:105]
v_pk_fma_f32 v[100:101], v[32:33], v[102:103], v[100:101]
v_pk_fma_f32 v[104:105], v[48:49], v[106:107], v[104:105]
v_pk_fma_f32 v[102:103], v[102:103], v[16:17], v[102:103]
v_pk_fma_f32 v[106:107], v[106:107], v[24:25], v[106:107]
v_pk_fma_f32 v[100:101], v[100:101], v[18:19], v[100:101]
v_pk_fma_f32 v[104:105], v[104:105], v[26:27], v[104:105]
v_pk_fma_f32 v[100:101], v[34:35], v[102:103], v[100:101]
v_pk_fma_f32 v[104:105], v[50:51], v[106:107], v[104:105]
v_pk_fma_f32 v[102:103], v[102:103], v[18:19], v[102:103]
v_pk_fma_f32 v[106:107], v[106:107], v[26:27], v[106:107]
v_pk_fma_f32 v[100:101], v[100:101], v[20:21], v[100:101]
v_pk_fma_f32 v[104:105], v[104:105], v[28:29], v[104:105]
v_pk_fma_f32 v[100:101], v[36:37], v[102:103], v[100:101]
v_pk_fma_f32 v[104:105], v[52:53], v[106:107], v[104:105]
v_pk_fma_f32 v[102:103], v[102:103], v[20:21], v[102:103]
v_pk_fma_f32 v[106:107], v[106:107], v[28:29], v[106:107]
v_pk_fma_f32 v[100:101], v[100:101], v[22:23], v[100:101]
v_pk_fma_f32 v[104:105], v[104:105], v[30:31], v[104:105]
v_pk_fma_f32 v[100:101], v[38:39], v[102:103], v[100:101]
v_pk_fma_f32 v[104:105], v[54:55], v[106:107], v[104:105]
v_pk_fma_f32 v[102:103], v[102:103], v[22:23], v[102:103]
v_pk_fma_f32 v[106:107], v[106:107], v[30:31], v[106:107]
FM1_J0:
ds_read_b64 v[82:83], v122 offset:768
v_mfma_f32_32x32x16_bf16 v[16:31], v[72:75], v[92:95], 0
v_exp_f32 v32, v40
v_exp_f32 v33, v41
v_exp_f32 v48, v56
v_exp_f32 v49, v57
v_mfma_f32_32x32x16_bf16 v[16:31], v[76:79], v[96:99], v[16:31]
v_exp_f32 v34, v42
v_exp_f32 v35, v43
v_exp_f32 v50, v58
v_exp_f32 v51, v59
v_mfma_f32_32x32x8_bf16 v[16:31], v[80:81], v[86:87], v[16:31]
v_exp_f32 v36, v44
v_exp_f32 v37, v45
v_exp_f32 v52, v60
v_exp_f32 v53, v61
v_exp_f32 v38, v46
v_exp_f32 v39, v47
v_exp_f32 v54, v62
v_exp_f32 v55, v63
s_waitcnt lgkmcnt(0)
s_cmp_lt_u32 s48, 2
s_cbranch_scc1 FM1_nr
s_add_u32 s54, s50, 16
v_cmp_ge_u32 vcc, s54, v127
s_bcnt1_i32_b64 s52, vcc
s_mul_i32 s53, s52, -4
s_mul_i32 s52, s52, 272
v_add_u32 v111, s52, v125
v_add3_u32 v110, v83, v124, s53
ds_read_b32 v85, v111 offset:0
ds_read_b32 v87, v111 offset:128
ds_read_b32 v83, v110
FM1_nr:
s_cmp_lt_u32 s49, 8
s_cbranch_scc1 FM1_C1
v_pk_fma_f32 v[100:101], v[100:101], v[32:33], v[100:101]
v_pk_fma_f32 v[104:105], v[104:105], v[48:49], v[104:105]
v_pk_fma_f32 v[100:101], v[40:41], v[102:103], v[100:101]
v_pk_fma_f32 v[104:105], v[56:57], v[106:107], v[104:105]
v_pk_fma_f32 v[102:103], v[102:103], v[32:33], v[102:103]
v_pk_fma_f32 v[106:107], v[106:107], v[48:49], v[106:107]
v_pk_fma_f32 v[100:101], v[100:101], v[34:35], v[100:101]
v_pk_fma_f32 v[104:105], v[104:105], v[50:51], v[104:105]
v_pk_fma_f32 v[100:101], v[42:43], v[102:103], v[100:101]
v_pk_fma_f32 v[104:105], v[58:59], v[106:107], v[104:105]
v_pk_fma_f32 v[102:103], v[102:103], v[34:35], v[102:103]
v_pk_fma_f32 v[106:107], v[106:107], v[50:51], v[106:107]
v_pk_fma_f32 v[100:101], v[100:101], v[36:37], v[100:101]
v_pk_fma_f32 v[104:105], v[104:105], v[52:53], v[104:105]
v_pk_fma_f32 v[100:101], v[44:45], v[102:103], v[100:101]
v_pk_fma_f32 v[104:105], v[60:61], v[106:107], v[104:105]
v_pk_fma_f32 v[102:103], v[102:103], v[36:37], v[102:103]
v_pk_fma_f32 v[106:107], v[106:107], v[52:53], v[106:107]
v_pk_fma_f32 v[100:101], v[100:101], v[38:39], v[100:101]
v_pk_fma_f32 v[104:105], v[104:105], v[54:55], v[104:105]
v_pk_fma_f32 v[100:101], v[46:47], v[102:103], v[100:101]
v_pk_fma_f32 v[104:105], v[62:63], v[106:107], v[104:105]
v_pk_fma_f32 v[102:103], v[102:103], v[38:39], v[102:103]
v_pk_fma_f32 v[106:107], v[106:107], v[54:55], v[106:107]
FM1_J1:
s_cmp_lt_u32 s48, 2
s_cbranch_scc1 FM1_nl
s_waitcnt vmcnt(0)
ds_read_b128 v[64:67], v120 offset:0
ds_read_b128 v[68:71], v121 offset:0
ds_read_b128 v[72:75], v120 offset:2048
ds_read_b128 v[76:79], v121 offset:2048
ds_read_u16 v116, v123 offset:1024
ds_read_u16 v118, v123 offset:1152
FM1_nl:
v_add_u32 v122, 512, v122
v_add_u32 v123, 512, v123
s_add_u32 s50, s50, 8
s_sub_u32 s49, s49, 8
s_sub_u32 s48, s48, 1
s_cmp_eq_u32 s48, 0
s_cbranch_scc1 FL0
s_branch FM0
FL0:
s_setprio 1
s_waitcnt lgkmcnt(0)
s_mov_b32 m0, 0
s_lshl_b32 s52, s65, 7
ds_read_addtid_b32 v124 offset:41600
ds_read_addtid_b32 v88 offset:41856
ds_read_addtid_b32 v120 offset:42112
ds_read_addtid_b32 v121 offset:42368
ds_read_addtid_b32 v122 offset:42624
ds_read_addtid_b32 v123 offset:42880
ds_read_addtid_b32 v125 offset:43136
ds_read_addtid_b32 v90 offset:43392
ds_read_addtid_b32 v91 offset:43648
s_waitcnt lgkmcnt(7)
v_add_u32 v88, s52, v88
s_mov_b32 m0, s56
s_add_u32 s52, s61, 0
buffer_load_dwordx4 v124, s[72:75], s52 offen lds
s_mov_b32 m0, s57
s_add_u32 s52, s61, 4096
buffer_load_dwordx4 v124, s[72:75], s52 offen lds
s_mov_b32 m0, s58
s_add_u32 s52, s61, 8192
buffer_load_dwordx4 v124, s[72:75], s52 offen lds
s_mov_b32 m0, s59
s_add_u32 s52, s61, 12288
buffer_load_dwordx4 v124, s[72:75], s52 offen lds
v_xor_b32 v89, 64, v88
ds_read_b128 v[64:67], v88 offset:61312
ds_read_b128 v[68:71], v89 offset:61312
s_mul_i32 s52, s28, 2112
s_add_u32 s52, s52, 69504
s_mul_i32 s53, s28, 576
s_add_u32 s53, s53, 96000
s_waitcnt lgkmcnt(2)
v_add_u32 v120, s52, v120
v_add_u32 v121, s53, v121
s_mul_i32 s52, s65, 144
s_add_u32 s52, s52, 96000
s_add_u32 s53, s52, s61
v_add_u32 v122, s52, v122
v_add_u32 v123, s53, v123
s_mul_i32 s52, s28, 1152
s_add_u32 s52, s52, 96000
s_lshl_b32 s53, s28, 11
s_add_u32 s53, s53, s64
s_lshl_b32 s53, s53, 7
v_add_u32 v90, s52, v90
v_add_u32 v91, s53, v91
v_add_u32 v125, s56, v125
v_exp_f32 v48, v0
v_exp_f32 v49, v1
v_exp_f32 v56, v16
v_exp_f32 v57, v17
v_exp_f32 v50, v2
v_exp_f32 v51, v3
v_exp_f32 v58, v18
v_exp_f32 v59, v19
v_exp_f32 v52, v4
v_exp_f32 v53, v5
v_exp_f32 v60, v20
v_exp_f32 v61, v21
v_exp_f32 v54, v6
v_exp_f32 v55, v7
v_exp_f32 v62, v22
v_exp_f32 v63, v23
s_cmp_lt_u32 s49, 4
s_cbranch_scc1 FL0_C0
v_pk_fma_f32 v[100:101], v[100:101], v[48:49], v[100:101]
v_pk_fma_f32 v[104:105], v[104:105], v[56:57], v[104:105]
v_pk_fma_f32 v[100:101], v[0:1], v[102:103], v[100:101]
v_pk_fma_f32 v[104:105], v[16:17], v[106:107], v[104:105]
v_pk_fma_f32 v[102:103], v[102:103], v[48:49], v[102:103]
v_pk_fma_f32 v[106:107], v[106:107], v[56:57], v[106:107]
v_pk_fma_f32 v[100:101], v[100:101], v[50:51], v[100:101]
v_pk_fma_f32 v[104:105], v[104:105], v[58:59], v[104:105]
v_pk_fma_f32 v[100:101], v[2:3], v[102:103], v[100:101]
v_pk_fma_f32 v[104:105], v[18:19], v[106:107], v[104:105]
v_pk_fma_f32 v[102:103], v[102:103], v[50:51], v[102:103]
v_pk_fma_f32 v[106:107], v[106:107], v[58:59], v[106:107]
v_pk_fma_f32 v[100:101], v[100:101], v[52:53], v[100:101]
v_pk_fma_f32 v[104:105], v[104:105], v[60:61], v[104:105]
v_pk_fma_f32 v[100:101], v[4:5], v[102:103], v[100:101]
v_pk_fma_f32 v[104:105], v[20:21], v[106:107], v[104:105]
v_pk_fma_f32 v[102:103], v[102:103], v[52:53], v[102:103]
v_pk_fma_f32 v[106:107], v[106:107], v[60:61], v[106:107]
v_pk_fma_f32 v[100:101], v[100:101], v[54:55], v[100:101]
v_pk_fma_f32 v[104:105], v[104:105], v[62:63], v[104:105]
v_pk_fma_f32 v[100:101], v[6:7], v[102:103], v[100:101]
v_pk_fma_f32 v[104:105], v[22:23], v[106:107], v[104:105]
v_pk_fma_f32 v[102:103], v[102:103], v[54:55], v[102:103]
v_pk_fma_f32 v[106:107], v[106:107], v[62:63], v[106:107]
FL0_J0:
s_setprio 0
s_waitcnt vmcnt(0)
ds_read_b64_tr_b16 v[72:73], v125 offset:0
ds_read_b64_tr_b16 v[74:75], v125 offset:128
ds_read_b64_tr_b16 v[76:77], v125 offset:1024
ds_read_b64_tr_b16 v[78:79], v125 offset:1152
ds_read_b64_tr_b16 v[80:81], v125 offset:2048
ds_read_b64_tr_b16 v[82:83], v125 offset:2176
ds_read_b64_tr_b16 v[84:85], v125 offset:3072
ds_read_b64_tr_b16 v[86:87], v125 offset:3200
s_cmp_lg_u32 s82, 0
s_cbranch_scc1 F_hfin
v_exp_f32 v0, v8
v_exp_f32 v1, v9
v_exp_f32 v16, v24
v_exp_f32 v17, v25
v_exp_f32 v2, v10
v_exp_f32 v3, v11
v_exp_f32 v18, v26
v_exp_f32 v19, v27
v_exp_f32 v4, v12
v_exp_f32 v5, v13
s_waitcnt lgkmcnt(0)
v_mfma_f32_16x16x32_bf16 v[116:119], v[72:75], v[64:67], 0
v_mfma_f32_16x16x32_bf16 v[116:119], v[76:79], v[68:71], v[116:119]
v_exp_f32 v20, v28
v_exp_f32 v21, v29
v_exp_f32 v6, v14
v_exp_f32 v7, v15
v_exp_f32 v22, v30
v_exp_f32 v23, v31
s_cmp_lt_u32 s49, 8
s_cbranch_scc1 FL0_C1
v_pk_fma_f32 v[100:101], v[100:101], v[0:1], v[100:101]
v_pk_fma_f32 v[104:105], v[104:105], v[16:17], v[104:105]
v_pk_fma_f32 v[100:101], v[8:9], v[102:103], v[100:101]
v_pk_fma_f32 v[104:105], v[24:25], v[106:107], v[104:105]
v_pk_fma_f32 v[102:103], v[102:103], v[0:1], v[102:103]
v_pk_fma_f32 v[106:107], v[106:107], v[16:17], v[106:107]
v_pk_fma_f32 v[100:101], v[100:101], v[2:3], v[100:101]
v_pk_fma_f32 v[104:105], v[104:105], v[18:19], v[104:105]
v_pk_fma_f32 v[100:101], v[10:11], v[102:103], v[100:101]
v_pk_fma_f32 v[104:105], v[26:27], v[106:107], v[104:105]
v_pk_fma_f32 v[102:103], v[102:103], v[2:3], v[102:103]
v_pk_fma_f32 v[106:107], v[106:107], v[18:19], v[106:107]
v_pk_fma_f32 v[100:101], v[100:101], v[4:5], v[100:101]
v_pk_fma_f32 v[104:105], v[104:105], v[20:21], v[104:105]
v_pk_fma_f32 v[100:101], v[12:13], v[102:103], v[100:101]
v_pk_fma_f32 v[104:105], v[28:29], v[106:107], v[104:105]
v_pk_fma_f32 v[102:103], v[102:103], v[4:5], v[102:103]
v_pk_fma_f32 v[106:107], v[106:107], v[20:21], v[106:107]
v_pk_fma_f32 v[100:101], v[100:101], v[6:7], v[100:101]
v_pk_fma_f32 v[104:105], v[104:105], v[22:23], v[104:105]
v_pk_fma_f32 v[100:101], v[14:15], v[102:103], v[100:101]
v_pk_fma_f32 v[104:105], v[30:31], v[106:107], v[104:105]
v_pk_fma_f32 v[102:103], v[102:103], v[6:7], v[102:103]
v_pk_fma_f32 v[106:107], v[106:107], v[22:23], v[106:107]
FL0_J1:
s_branch F_fin
FL1n:
s_nop 15
FL1:
s_setprio 1
s_waitcnt lgkmcnt(0)
s_mov_b32 m0, 0
s_lshl_b32 s52, s65, 7
ds_read_addtid_b32 v124 offset:41600
ds_read_addtid_b32 v88 offset:41856
ds_read_addtid_b32 v120 offset:42112
ds_read_addtid_b32 v121 offset:42368
ds_read_addtid_b32 v122 offset:42624
ds_read_addtid_b32 v123 offset:42880
ds_read_addtid_b32 v125 offset:43136
ds_read_addtid_b32 v90 offset:43392
ds_read_addtid_b32 v91 offset:43648
s_waitcnt lgkmcnt(7)
v_add_u32 v88, s52, v88
s_mov_b32 m0, s56
s_add_u32 s52, s61, 0
buffer_load_dwordx4 v124, s[72:75], s52 offen lds
s_mov_b32 m0, s57
s_add_u32 s52, s61, 4096
buffer_load_dwordx4 v124, s[72:75], s52 offen lds
s_mov_b32 m0, s58
s_add_u32 s52, s61, 8192
buffer_load_dwordx4 v124, s[72:75], s52 offen lds
s_mov_b32 m0, s59
s_add_u32 s52, s61, 12288
buffer_load_dwordx4 v124, s[72:75], s52 offen lds
v_xor_b32 v89, 64, v88
ds_read_b128 v[64:67], v88 offset:61312
ds_read_b128 v[68:71], v89 offset:61312
s_mul_i32 s52, s28, 2112
s_add_u32 s52, s52, 69504
s_mul_i32 s53, s28, 576
s_add_u32 s53, s53, 96000
s_waitcnt lgkmcnt(2)
v_add_u32 v120, s52, v120
v_add_u32 v121, s53, v121
s_mul_i32 s52, s65, 144
s_add_u32 s52, s52, 96000
s_add_u32 s53, s52, s61
v_add_u32 v122, s52, v122
v_add_u32 v123, s53, v123
s_mul_i32 s52, s28, 1152
s_add_u32 s52, s52, 96000
s_lshl_b32 s53, s28, 11
s_add_u32 s53, s53, s64
s_lshl_b32 s53, s53, 7
v_add_u32 v90, s52, v90
v_add_u32 v91, s53, v91
v_add_u32 v125, s56, v125
v_exp_f32 v16, v32
v_exp_f32 v17, v33
v_exp_f32 v24, v48
v_exp_f32 v25, v49
v_exp_f32 v18, v34
v_exp_f32 v19, v35
v_exp_f32 v26, v50
v_exp_f32 v27, v51
v_exp_f32 v20, v36
v_exp_f32 v21, v37
v_exp_f32 v28, v52
v_exp_f32 v29, v53
v_exp_f32 v22, v38
v_exp_f32 v23, v39
v_exp_f32 v30, v54
v_exp_f32 v31, v55
s_cmp_lt_u32 s49, 4
s_cbranch_scc1 FL1_C0
v_pk_fma_f32 v[100:101], v[100:101], v[16:17], v[100:101]
v_pk_fma_f32 v[104:105], v[104:105], v[24:25], v[104:105]
v_pk_fma_f32 v[100:101], v[32:33], v[102:103], v[100:101]
v_pk_fma_f32 v[104:105], v[48:49], v[106:107], v[104:105]
v_pk_fma_f32 v[102:103], v[102:103], v[16:17], v[102:103]
v_pk_fma_f32 v[106:107], v[106:107], v[24:25], v[106:107]
v_pk_fma_f32 v[100:101], v[100:101], v[18:19], v[100:101]
v_pk_fma_f32 v[104:105], v[104:105], v[26:27], v[104:105]
v_pk_fma_f32 v[100:101], v[34:35], v[102:103], v[100:101]
v_pk_fma_f32 v[104:105], v[50:51], v[106:107], v[104:105]
v_pk_fma_f32 v[102:103], v[102:103], v[18:19], v[102:103]
v_pk_fma_f32 v[106:107], v[106:107], v[26:27], v[106:107]
v_pk_fma_f32 v[100:101], v[100:101], v[20:21], v[100:101]
v_pk_fma_f32 v[104:105], v[104:105], v[28:29], v[104:105]
v_pk_fma_f32 v[100:101], v[36:37], v[102:103], v[100:101]
v_pk_fma_f32 v[104:105], v[52:53], v[106:107], v[104:105]
v_pk_fma_f32 v[102:103], v[102:103], v[20:21], v[102:103]
v_pk_fma_f32 v[106:107], v[106:107], v[28:29], v[106:107]
v_pk_fma_f32 v[100:101], v[100:101], v[22:23], v[100:101]
v_pk_fma_f32 v[104:105], v[104:105], v[30:31], v[104:105]
v_pk_fma_f32 v[100:101], v[38:39], v[102:103], v[100:101]
v_pk_fma_f32 v[104:105], v[54:55], v[106:107], v[104:105]
v_pk_fma_f32 v[102:103], v[102:103], v[22:23], v[102:103]
v_pk_fma_f32 v[106:107], v[106:107], v[30:31], v[106:107]
FL1_J0:
s_setprio 0
s_waitcnt vmcnt(0)
ds_read_b64_tr_b16 v[72:73], v125 offset:0
ds_read_b64_tr_b16 v[74:75], v125 offset:128
ds_read_b64_tr_b16 v[76:77], v125 offset:1024
ds_read_b64_tr_b16 v[78:79], v125 offset:1152
ds_read_b64_tr_b16 v[80:81], v125 offset:2048
ds_read_b64_tr_b16 v[82:83], v125 offset:2176
ds_read_b64_tr_b16 v[84:85], v125 offset:3072
ds_read_b64_tr_b16 v[86:87], v125 offset:3200
s_cmp_lg_u32 s82, 0
s_cbranch_scc1 F_hfin
v_exp_f32 v32, v40
v_exp_f32 v33, v41
v_exp_f32 v48, v56
v_exp_f32 v49, v57
v_exp_f32 v34, v42
v_exp_f32 v35, v43
v_exp_f32 v50, v58
v_exp_f32 v51, v59
v_exp_f32 v36, v44
v_exp_f32 v37, v45
s_waitcnt lgkmcnt(0)
v_mfma_f32_16x16x32_bf16 v[116:119], v[72:75], v[64:67], 0
v_mfma_f32_16x16x32_bf16 v[116:119], v[76:79], v[68:71], v[116:119]
v_exp_f32 v52, v60
v_exp_f32 v53, v61
v_exp_f32 v38, v46
v_exp_f32 v39, v47
v_exp_f32 v54, v62
v_exp_f32 v55, v63
s_cmp_lt_u32 s49, 8
s_cbranch_scc1 FL1_C1
v_pk_fma_f32 v[100:101], v[100:101], v[32:33], v[100:101]
v_pk_fma_f32 v[104:105], v[104:105], v[48:49], v[104:105]
v_pk_fma_f32 v[100:101], v[40:41], v[102:103], v[100:101]
v_pk_fma_f32 v[104:105], v[56:57], v[106:107], v[104:105]
v_pk_fma_f32 v[102:103], v[102:103], v[32:33], v[102:103]
v_pk_fma_f32 v[106:107], v[106:107], v[48:49], v[106:107]
v_pk_fma_f32 v[100:101], v[100:101], v[34:35], v[100:101]
v_pk_fma_f32 v[104:105], v[104:105], v[50:51], v[104:105]
v_pk_fma_f32 v[100:101], v[42:43], v[102:103], v[100:101]
v_pk_fma_f32 v[104:105], v[58:59], v[106:107], v[104:105]
v_pk_fma_f32 v[102:103], v[102:103], v[34:35], v[102:103]
v_pk_fma_f32 v[106:107], v[106:107], v[50:51], v[106:107]
v_pk_fma_f32 v[100:101], v[100:101], v[36:37], v[100:101]
v_pk_fma_f32 v[104:105], v[104:105], v[52:53], v[104:105]
v_pk_fma_f32 v[100:101], v[44:45], v[102:103], v[100:101]
v_pk_fma_f32 v[104:105], v[60:61], v[106:107], v[104:105]
v_pk_fma_f32 v[102:103], v[102:103], v[36:37], v[102:103]
v_pk_fma_f32 v[106:107], v[106:107], v[52:53], v[106:107]
v_pk_fma_f32 v[100:101], v[100:101], v[38:39], v[100:101]
v_pk_fma_f32 v[104:105], v[104:105], v[54:55], v[104:105]
v_pk_fma_f32 v[100:101], v[46:47], v[102:103], v[100:101]
v_pk_fma_f32 v[104:105], v[62:63], v[106:107], v[104:105]
v_pk_fma_f32 v[102:103], v[102:103], v[38:39], v[102:103]
v_pk_fma_f32 v[106:107], v[106:107], v[54:55], v[106:107]
FL1_J1:
F_fin:
v_pk_mul_f32 v[110:111], v[100:101], v[102:103] op_sel:[0,1] op_sel_hi:[1,0]
v_mul_f32 v114, v102, v103
v_add_f32 v112, v110, v111
v_pk_mul_f32 v[110:111], v[104:105], v[106:107] op_sel:[0,1] op_sel_hi:[1,0]
v_mul_f32 v115, v106, v107
v_add_f32 v113, v110, v111
v_pk_fma_f32 v[108:109], v[114:115], 4.0, v[108:109] op_sel_hi:[1,0,1]
v_rcp_f32 v114, v114
v_rcp_f32 v115, v115
s_nop 0
v_pk_mul_f32 v[112:113], v[112:113], v[114:115]
v_cvt_f64_f32 v[110:111], v112
v_cvt_f64_f32 v[114:115], v113
ds_add_f64 v126, v[110:111]
ds_add_f64 v126, v[114:115] offset:256
v_pk_fma_f32 v[108:109], v[112:113], 0, v[108:109] op_sel_hi:[1,0,1]
s_branch K2_join
F_hfin:
v_pk_mul_f32 v[110:111], v[100:101], v[102:103] op_sel:[0,1] op_sel_hi:[1,0]
v_mul_f32 v114, v102, v103
v_add_f32 v112, v110, v111
v_pk_mul_f32 v[110:111], v[104:105], v[106:107] op_sel:[0,1] op_sel_hi:[1,0]
v_mul_f32 v115, v106, v107
v_add_f32 v113, v110, v111
v_pk_fma_f32 v[108:109], v[114:115], 4.0, v[108:109] op_sel_hi:[1,0,1]
v_rcp_f32 v114, v114
v_rcp_f32 v115, v115
s_nop 0
v_pk_mul_f32 v[112:113], v[112:113], v[114:115]
v_cvt_f64_f32 v[110:111], v112
v_cvt_f64_f32 v[114:115], v113
ds_add_f64 v126, v[110:111]
ds_add_f64 v126, v[114:115] offset:256
v_pk_fma_f32 v[108:109], v[112:113], 0, v[108:109] op_sel_hi:[1,0,1]
s_waitcnt lgkmcnt(0)
v_mfma_f32_16x16x32_bf16 v[116:119], v[72:75], v[64:67], 0
v_mfma_f32_16x16x32_bf16 v[116:119], v[76:79], v[68:71], v[116:119]
s_branch K2_join
FM0_lo:
s_nop 0
s_cmp_eq_u32 s48, 2
s_cbranch_scc1 FM0_g
s_setprio 2
s_waitcnt lgkmcnt(0)
s_branch FM0_ng
FM0_C0:
s_cmp_eq_u32 s49, 0
s_cbranch_scc1 FM0_F0
v_pk_fma_f32 v[100:101], v[100:101], v[48:49], v[100:101]
v_pk_fma_f32 v[104:105], v[104:105], v[56:57], v[104:105]
v_pk_fma_f32 v[100:101], v[0:1], v[102:103], v[100:101]
v_pk_fma_f32 v[104:105], v[16:17], v[106:107], v[104:105]
v_pk_fma_f32 v[102:103], v[102:103], v[48:49], v[102:103]
v_pk_fma_f32 v[106:107], v[106:107], v[56:57], v[106:107]
FM0_A0:
s_cmp_eq_u32 s49, 1
s_cbranch_scc1 FM0_F1
v_pk_fma_f32 v[100:101], v[100:101], v[50:51], v[100:101]
v_pk_fma_f32 v[104:105], v[104:105], v[58:59], v[104:105]
v_pk_fma_f32 v[100:101], v[2:3], v[102:103], v[100:101]
v_pk_fma_f32 v[104:105], v[18:19], v[106:107], v[104:105]
v_pk_fma_f32 v[102:103], v[102:103], v[50:51], v[102:103]
v_pk_fma_f32 v[106:107], v[106:107], v[58:59], v[106:107]
FM0_A1:
s_cmp_eq_u32 s49, 2
s_cbranch_scc1 FM0_F2
v_pk_fma_f32 v[100:101], v[100:101], v[52:53], v[100:101]
v_pk_fma_f32 v[104:105], v[104:105], v[60:61], v[104:105]
v_pk_fma_f32 v[100:101], v[4:5], v[102:103], v[100:101]
v_pk_fma_f32 v[104:105], v[20:21], v[106:107], v[104:105]
v_pk_fma_f32 v[102:103], v[102:103], v[52:53], v[102:103]
v_pk_fma_f32 v[106:107], v[106:107], v[60:61], v[106:107]
FM0_A2:
s_cmp_eq_u32 s49, 3
s_cbranch_scc1 FM0_F3
v_pk_fma_f32 v[100:101], v[100:101], v[54:55], v[100:101]
v_pk_fma_f32 v[104:105], v[104:105], v[62:63], v[104:105]
v_pk_fma_f32 v[100:101], v[6:7], v[102:103], v[100:101]
v_pk_fma_f32 v[104:105], v[22:23], v[106:107], v[104:105]
v_pk_fma_f32 v[102:103], v[102:103], v[54:55], v[102:103]
v_pk_fma_f32 v[106:107], v[106:107], v[62:63], v[106:107]
s_branch FM0_J0
FM0_C1:
s_cmp_eq_u32 s49, 4
s_cbranch_scc1 FM0_F4
v_pk_fma_f32 v[100:101], v[100:101], v[0:1], v[100:101]
v_pk_fma_f32 v[104:105], v[104:105], v[16:17], v[104:105]
v_pk_fma_f32 v[100:101], v[8:9], v[102:103], v[100:101]
v_pk_fma_f32 v[104:105], v[24:25], v[106:107], v[104:105]
v_pk_fma_f32 v[102:103], v[102:103], v[0:1], v[102:103]
v_pk_fma_f32 v[106:107], v[106:107], v[16:17], v[106:107]
FM0_A4:
s_cmp_eq_u32 s49, 5
s_cbranch_scc1 FM0_F5
v_pk_fma_f32 v[100:101], v[100:101], v[2:3], v[100:101]
v_pk_fma_f32 v[104:105], v[104:105], v[18:19], v[104:105]
v_pk_fma_f32 v[100:101], v[10:11], v[102:103], v[100:101]
v_pk_fma_f32 v[104:105], v[26:27], v[106:107], v[104:105]
v_pk_fma_f32 v[102:103], v[102:103], v[2:3], v[102:103]
v_pk_fma_f32 v[106:107], v[106:107], v[18:19], v[106:107]
FM0_A5:
s_cmp_eq_u32 s49, 6
s_cbranch_scc1 FM0_F6
v_pk_fma_f32 v[100:101], v[100:101], v[4:5], v[100:101]
v_pk_fma_f32 v[104:105], v[104:105], v[20:21], v[104:105]
v_pk_fma_f32 v[100:101], v[12:13], v[102:103], v[100:101]
v_pk_fma_f32 v[104:105], v[28:29], v[106:107], v[104:105]
v_pk_fma_f32 v[102:103], v[102:103], v[4:5], v[102:103]
v_pk_fma_f32 v[106:107], v[106:107], v[20:21], v[106:107]
FM0_A6:
s_cmp_eq_u32 s49, 7
s_cbranch_scc1 FM0_F7
v_pk_fma_f32 v[100:101], v[100:101], v[6:7], v[100:101]
v_pk_fma_f32 v[104:105], v[104:105], v[22:23], v[104:105]
v_pk_fma_f32 v[100:101], v[14:15], v[102:103], v[100:101]
v_pk_fma_f32 v[104:105], v[30:31], v[106:107], v[104:105]
v_pk_fma_f32 v[102:103], v[102:103], v[6:7], v[102:103]
v_pk_fma_f32 v[106:107], v[106:107], v[22:23], v[106:107]
s_branch FM0_J1
FM0_F0:
s_add_u32 s51, s51, 1
v_readlane_b32 s52, v127, s51
v_pk_mul_f32 v[110:111], v[100:101], v[102:103] op_sel:[0,1] op_sel_hi:[1,0]
v_mul_f32 v114, v102, v103
v_add_f32 v112, v110, v111
v_pk_mul_f32 v[110:111], v[104:105], v[106:107] op_sel:[0,1] op_sel_hi:[1,0]
v_mul_f32 v115, v106, v107
v_add_f32 v113, v110, v111
v_pk_fma_f32 v[108:109], v[114:115], 4.0, v[108:109] op_sel_hi:[1,0,1]
v_rcp_f32 v114, v114
v_rcp_f32 v115, v115
s_nop 0
v_pk_mul_f32 v[112:113], v[112:113], v[114:115]
v_cvt_f64_f32 v[110:111], v112
v_cvt_f64_f32 v[114:115], v113
ds_add_f64 v126, v[110:111]
ds_add_f64 v126, v[114:115] offset:256
v_pk_fma_f32 v[108:109], v[112:113], 0, v[108:109] op_sel_hi:[1,0,1]
v_add_u32 v126, 528, v126
s_sub_u32 s49, s52, s50
v_pk_add_f32 v[102:103], v[48:49], 1.0 op_sel_hi:[1,0]
v_pk_add_f32 v[100:101], v[0:1], 0 op_sel_hi:[1,0]
v_pk_add_f32 v[106:107], v[56:57], 1.0 op_sel_hi:[1,0]
v_pk_add_f32 v[104:105], v[16:17], 0 op_sel_hi:[1,0]
s_branch FM0_A0
FM0_F1:
s_add_u32 s51, s51, 1
v_readlane_b32 s52, v127, s51
v_pk_mul_f32 v[110:111], v[100:101], v[102:103] op_sel:[0,1] op_sel_hi:[1,0]
v_mul_f32 v114, v102, v103
v_add_f32 v112, v110, v111
v_pk_mul_f32 v[110:111], v[104:105], v[106:107] op_sel:[0,1] op_sel_hi:[1,0]
v_mul_f32 v115, v106, v107
v_add_f32 v113, v110, v111
v_pk_fma_f32 v[108:109], v[114:115], 4.0, v[108:109] op_sel_hi:[1,0,1]
v_rcp_f32 v114, v114
v_rcp_f32 v115, v115
s_nop 0
v_pk_mul_f32 v[112:113], v[112:113], v[114:115]
v_cvt_f64_f32 v[110:111], v112
v_cvt_f64_f32 v[114:115], v113
ds_add_f64 v126, v[110:111]
ds_add_f64 v126, v[114:115] offset:256
v_pk_fma_f32 v[108:109], v[112:113], 0, v[108:109] op_sel_hi:[1,0,1]
v_add_u32 v126, 528, v126
s_sub_u32 s49, s52, s50
v_pk_add_f32 v[102:103], v[50:51], 1.0 op_sel_hi:[1,0]
v_pk_add_f32 v[100:101], v[2:3], 0 op_sel_hi:[1,0]
v_pk_add_f32 v[106:107], v[58:59], 1.0 op_sel_hi:[1,0]
v_pk_add_f32 v[104:105], v[18:19], 0 op_sel_hi:[1,0]
s_branch FM0_A1
FM0_F2:
s_add_u32 s51, s51, 1
v_readlane_b32 s52, v127, s51
v_pk_mul_f32 v[110:111], v[100:101], v[102:103] op_sel:[0,1] op_sel_hi:[1,0]
v_mul_f32 v114, v102, v103
v_add_f32 v112, v110, v111
v_pk_mul_f32 v[110:111], v[104:105], v[106:107] op_sel:[0,1] op_sel_hi:[1,0]
v_mul_f32 v115, v106, v107
v_add_f32 v113, v110, v111
v_pk_fma_f32 v[108:109], v[114:115], 4.0, v[108:109] op_sel_hi:[1,0,1]
v_rcp_f32 v114, v114
v_rcp_f32 v115, v115
s_nop 0
v_pk_mul_f32 v[112:113], v[112:113], v[114:115]
v_cvt_f64_f32 v[110:111], v112
v_cvt_f64_f32 v[114:115], v113
ds_add_f64 v126, v[110:111]
ds_add_f64 v126, v[114:115] offset:256
v_pk_fma_f32 v[108:109], v[112:113], 0, v[108:109] op_sel_hi:[1,0,1]
v_add_u32 v126, 528, v126
s_sub_u32 s49, s52, s50
v_pk_add_f32 v[102:103], v[52:53], 1.0 op_sel_hi:[1,0]
v_pk_add_f32 v[100:101], v[4:5], 0 op_sel_hi:[1,0]
v_pk_add_f32 v[106:107], v[60:61], 1.0 op_sel_hi:[1,0]
v_pk_add_f32 v[104:105], v[20:21], 0 op_sel_hi:[1,0]
s_branch FM0_A2
FM0_F3:
s_add_u32 s51, s51, 1
v_readlane_b32 s52, v127, s51
v_pk_mul_f32 v[110:111], v[100:101], v[102:103] op_sel:[0,1] op_sel_hi:[1,0]
v_mul_f32 v114, v102, v103
v_add_f32 v112, v110, v111
v_pk_mul_f32 v[110:111], v[104:105], v[106:107] op_sel:[0,1] op_sel_hi:[1,0]
v_mul_f32 v115, v106, v107
v_add_f32 v113, v110, v111
v_pk_fma_f32 v[108:109], v[114:115], 4.0, v[108:109] op_sel_hi:[1,0,1]
v_rcp_f32 v114, v114
v_rcp_f32 v115, v115
s_nop 0
v_pk_mul_f32 v[112:113], v[112:113], v[114:115]
v_cvt_f64_f32 v[110:111], v112
v_cvt_f64_f32 v[114:115], v113
ds_add_f64 v126, v[110:111]
ds_add_f64 v126, v[114:115] offset:256
v_pk_fma_f32 v[108:109], v[112:113], 0, v[108:109] op_sel_hi:[1,0,1]
v_add_u32 v126, 528, v126
s_sub_u32 s49, s52, s50
v_pk_add_f32 v[102:103], v[54:55], 1.0 op_sel_hi:[1,0]
v_pk_add_f32 v[100:101], v[6:7], 0 op_sel_hi:[1,0]
v_pk_add_f32 v[106:107], v[62:63], 1.0 op_sel_hi:[1,0]
v_pk_add_f32 v[104:105], v[22:23], 0 op_sel_hi:[1,0]
s_branch FM0_J0
FM0_F4:
s_add_u32 s51, s51, 1
v_readlane_b32 s52, v127, s51
v_pk_mul_f32 v[110:111], v[100:101], v[102:103] op_sel:[0,1] op_sel_hi:[1,0]
v_mul_f32 v114, v102, v103
v_add_f32 v112, v110, v111
v_pk_mul_f32 v[110:111], v[104:105], v[106:107] op_sel:[0,1] op_sel_hi:[1,0]
v_mul_f32 v115, v106, v107
v_add_f32 v113, v110, v111
v_pk_fma_f32 v[108:109], v[114:115], 4.0, v[108:109] op_sel_hi:[1,0,1]
v_rcp_f32 v114, v114
v_rcp_f32 v115, v115
s_nop 0
v_pk_mul_f32 v[112:113], v[112:113], v[114:115]
v_cvt_f64_f32 v[110:111], v112
v_cvt_f64_f32 v[114:115], v113
ds_add_f64 v126, v[110:111]
ds_add_f64 v126, v[114:115] offset:256
v_pk_fma_f32 v[108:109], v[112:113], 0, v[108:109] op_sel_hi:[1,0,1]
v_add_u32 v126, 528, v126
s_sub_u32 s49, s52, s50
v_pk_add_f32 v[102:103], v[0:1], 1.0 op_sel_hi:[1,0]
v_pk_add_f32 v[100:101], v[8:9], 0 op_sel_hi:[1,0]
v_pk_add_f32 v[106:107], v[16:17], 1.0 op_sel_hi:[1,0]
v_pk_add_f32 v[104:105], v[24:25], 0 op_sel_hi:[1,0]
s_branch FM0_A4
FM0_F5:
s_add_u32 s51, s51, 1
v_readlane_b32 s52, v127, s51
v_pk_mul_f32 v[110:111], v[100:101], v[102:103] op_sel:[0,1] op_sel_hi:[1,0]
v_mul_f32 v114, v102, v103
v_add_f32 v112, v110, v111
v_pk_mul_f32 v[110:111], v[104:105], v[106:107] op_sel:[0,1] op_sel_hi:[1,0]
v_mul_f32 v115, v106, v107
v_add_f32 v113, v110, v111
v_pk_fma_f32 v[108:109], v[114:115], 4.0, v[108:109] op_sel_hi:[1,0,1]
v_rcp_f32 v114, v114
v_rcp_f32 v115, v115
s_nop 0
v_pk_mul_f32 v[112:113], v[112:113], v[114:115]
v_cvt_f64_f32 v[110:111], v112
v_cvt_f64_f32 v[114:115], v113
ds_add_f64 v126, v[110:111]
ds_add_f64 v126, v[114:115] offset:256
v_pk_fma_f32 v[108:109], v[112:113], 0, v[108:109] op_sel_hi:[1,0,1]
v_add_u32 v126, 528, v126
s_sub_u32 s49, s52, s50
v_pk_add_f32 v[102:103], v[2:3], 1.0 op_sel_hi:[1,0]
v_pk_add_f32 v[100:101], v[10:11], 0 op_sel_hi:[1,0]
v_pk_add_f32 v[106:107], v[18:19], 1.0 op_sel_hi:[1,0]
v_pk_add_f32 v[104:105], v[26:27], 0 op_sel_hi:[1,0]
s_branch FM0_A5
FM0_F6:
s_add_u32 s51, s51, 1
v_readlane_b32 s52, v127, s51
v_pk_mul_f32 v[110:111], v[100:101], v[102:103] op_sel:[0,1] op_sel_hi:[1,0]
v_mul_f32 v114, v102, v103
v_add_f32 v112, v110, v111
v_pk_mul_f32 v[110:111], v[104:105], v[106:107] op_sel:[0,1] op_sel_hi:[1,0]
v_mul_f32 v115, v106, v107
v_add_f32 v113, v110, v111
v_pk_fma_f32 v[108:109], v[114:115], 4.0, v[108:109] op_sel_hi:[1,0,1]
v_rcp_f32 v114, v114
v_rcp_f32 v115, v115
s_nop 0
v_pk_mul_f32 v[112:113], v[112:113], v[114:115]
v_cvt_f64_f32 v[110:111], v112
v_cvt_f64_f32 v[114:115], v113
ds_add_f64 v126, v[110:111]
ds_add_f64 v126, v[114:115] offset:256
v_pk_fma_f32 v[108:109], v[112:113], 0, v[108:109] op_sel_hi:[1,0,1]
v_add_u32 v126, 528, v126
s_sub_u32 s49, s52, s50
v_pk_add_f32 v[102:103], v[4:5], 1.0 op_sel_hi:[1,0]
v_pk_add_f32 v[100:101], v[12:13], 0 op_sel_hi:[1,0]
v_pk_add_f32 v[106:107], v[20:21], 1.0 op_sel_hi:[1,0]
v_pk_add_f32 v[104:105], v[28:29], 0 op_sel_hi:[1,0]
s_branch FM0_A6
FM0_F7:
s_add_u32 s51, s51, 1
v_readlane_b32 s52, v127, s51
v_pk_mul_f32 v[110:111], v[100:101], v[102:103] op_sel:[0,1] op_sel_hi:[1,0]
v_mul_f32 v114, v102, v103
v_add_f32 v112, v110, v111
v_pk_mul_f32 v[110:111], v[104:105], v[106:107] op_sel:[0,1] op_sel_hi:[1,0]
v_mul_f32 v115, v106, v107
v_add_f32 v113, v110, v111
v_pk_fma_f32 v[108:109], v[114:115], 4.0, v[108:109] op_sel_hi:[1,0,1]
v_rcp_f32 v114, v114
v_rcp_f32 v115, v115
s_nop 0
v_pk_mul_f32 v[112:113], v[112:113], v[114:115]
v_cvt_f64_f32 v[110:111], v112
v_cvt_f64_f32 v[114:115], v113
ds_add_f64 v126, v[110:111]
ds_add_f64 v126, v[114:115] offset:256
v_pk_fma_f32 v[108:109], v[112:113], 0, v[108:109] op_sel_hi:[1,0,1]
v_add_u32 v126, 528, v126
s_sub_u32 s49, s52, s50
v_pk_add_f32 v[102:103], v[6:7], 1.0 op_sel_hi:[1,0]
v_pk_add_f32 v[100:101], v[14:15], 0 op_sel_hi:[1,0]
v_pk_add_f32 v[106:107], v[22:23], 1.0 op_sel_hi:[1,0]
v_pk_add_f32 v[104:105], v[30:31], 0 op_sel_hi:[1,0]
s_branch FM0_J1
FM1_lo:
s_nop 0
s_cmp_eq_u32 s48, 2
s_cbranch_scc1 FM1_g
s_setprio 2
s_waitcnt lgkmcnt(0)
s_branch FM1_ng
FM1_C0:
s_cmp_eq_u32 s49, 0
s_cbranch_scc1 FM1_F0
v_pk_fma_f32 v[100:101], v[100:101], v[16:17], v[100:101]
v_pk_fma_f32 v[104:105], v[104:105], v[24:25], v[104:105]
v_pk_fma_f32 v[100:101], v[32:33], v[102:103], v[100:101]
v_pk_fma_f32 v[104:105], v[48:49], v[106:107], v[104:105]
v_pk_fma_f32 v[102:103], v[102:103], v[16:17], v[102:103]
v_pk_fma_f32 v[106:107], v[106:107], v[24:25], v[106:107]
FM1_A0:
s_cmp_eq_u32 s49, 1
s_cbranch_scc1 FM1_F1
v_pk_fma_f32 v[100:101], v[100:101], v[18:19], v[100:101]
v_pk_fma_f32 v[104:105], v[104:105], v[26:27], v[104:105]
v_pk_fma_f32 v[100:101], v[34:35], v[102:103], v[100:101]
v_pk_fma_f32 v[104:105], v[50:51], v[106:107], v[104:105]
v_pk_fma_f32 v[102:103], v[102:103], v[18:19], v[102:103]
v_pk_fma_f32 v[106:107], v[106:107], v[26:27], v[106:107]
FM1_A1:
s_cmp_eq_u32 s49, 2
s_cbranch_scc1 FM1_F2
v_pk_fma_f32 v[100:101], v[100:101], v[20:21], v[100:101]
v_pk_fma_f32 v[104:105], v[104:105], v[28:29], v[104:105]
v_pk_fma_f32 v[100:101], v[36:37], v[102:103], v[100:101]
v_pk_fma_f32 v[104:105], v[52:53], v[106:107], v[104:105]
v_pk_fma_f32 v[102:103], v[102:103], v[20:21], v[102:103]
v_pk_fma_f32 v[106:107], v[106:107], v[28:29], v[106:107]
FM1_A2:
s_cmp_eq_u32 s49, 3
s_cbranch_scc1 FM1_F3
v_pk_fma_f32 v[100:101], v[100:101], v[22:23], v[100:101]
v_pk_fma_f32 v[104:105], v[104:105], v[30:31], v[104:105]
v_pk_fma_f32 v[100:101], v[38:39], v[102:103], v[100:101]
v_pk_fma_f32 v[104:105], v[54:55], v[106:107], v[104:105]
v_pk_fma_f32 v[102:103], v[102:103], v[22:23], v[102:103]
v_pk_fma_f32 v[106:107], v[106:107], v[30:31], v[106:107]
s_branch FM1_J0
FM1_C1:
s_cmp_eq_u32 s49, 4
s_cbranch_scc1 FM1_F4
v_pk_fma_f32 v[100:101], v[100:101], v[32:33], v[100:101]
v_pk_fma_f32 v[104:105], v[104:105], v[48:49], v[104:105]
v_pk_fma_f32 v[100:101], v[40:41], v[102:103], v[100:101]
v_pk_fma_f32 v[104:105], v[56:57], v[106:107], v[104:105]
v_pk_fma_f32 v[102:103], v[102:103], v[32:33], v[102:103]
v_pk_fma_f32 v[106:107], v[106:107], v[48:49], v[106:107]
FM1_A4:
s_cmp_eq_u32 s49, 5
s_cbranch_scc1 FM1_F5
v_pk_fma_f32 v[100:101], v[100:101], v[34:35], v[100:101]
v_pk_fma_f32 v[104:105], v[104:105], v[50:51], v[104:105]
v_pk_fma_f32 v[100:101], v[42:43], v[102:103], v[100:101]
v_pk_fma_f32 v[104:105], v[58:59], v[106:107], v[104:105]
v_pk_fma_f32 v[102:103], v[102:103], v[34:35], v[102:103]
v_pk_fma_f32 v[106:107], v[106:107], v[50:51], v[106:107]
FM1_A5:
s_cmp_eq_u32 s49, 6
s_cbranch_scc1 FM1_F6
v_pk_fma_f32 v[100:101], v[100:101], v[36:37], v[100:101]
v_pk_fma_f32 v[104:105], v[104:105], v[52:53], v[104:105]
v_pk_fma_f32 v[100:101], v[44:45], v[102:103], v[100:101]
v_pk_fma_f32 v[104:105], v[60:61], v[106:107], v[104:105]
v_pk_fma_f32 v[102:103], v[102:103], v[36:37], v[102:103]
v_pk_fma_f32 v[106:107], v[106:107], v[52:53], v[106:107]
FM1_A6:
s_cmp_eq_u32 s49, 7
s_cbranch_scc1 FM1_F7
v_pk_fma_f32 v[100:101], v[100:101], v[38:39], v[100:101]
v_pk_fma_f32 v[104:105], v[104:105], v[54:55], v[104:105]
v_pk_fma_f32 v[100:101], v[46:47], v[102:103], v[100:101]
v_pk_fma_f32 v[104:105], v[62:63], v[106:107], v[104:105]
v_pk_fma_f32 v[102:103], v[102:103], v[38:39], v[102:103]
v_pk_fma_f32 v[106:107], v[106:107], v[54:55], v[106:107]
s_branch FM1_J1
FM1_F0:
s_add_u32 s51, s51, 1
v_readlane_b32 s52, v127, s51
v_pk_mul_f32 v[110:111], v[100:101], v[102:103] op_sel:[0,1] op_sel_hi:[1,0]
v_mul_f32 v114, v102, v103
v_add_f32 v112, v110, v111
v_pk_mul_f32 v[110:111], v[104:105], v[106:107] op_sel:[0,1] op_sel_hi:[1,0]
v_mul_f32 v115, v106, v107
v_add_f32 v113, v110, v111
v_pk_fma_f32 v[108:109], v[114:115], 4.0, v[108:109] op_sel_hi:[1,0,1]
v_rcp_f32 v114, v114
v_rcp_f32 v115, v115
s_nop 0
v_pk_mul_f32 v[112:113], v[112:113], v[114:115]
v_cvt_f64_f32 v[110:111], v112
v_cvt_f64_f32 v[114:115], v113
ds_add_f64 v126, v[110:111]
ds_add_f64 v126, v[114:115] offset:256
v_pk_fma_f32 v[108:109], v[112:113], 0, v[108:109] op_sel_hi:[1,0,1]
v_add_u32 v126, 528, v126
s_sub_u32 s49, s52, s50
v_pk_add_f32 v[102:103], v[16:17], 1.0 op_sel_hi:[1,0]
v_pk_add_f32 v[100:101], v[32:33], 0 op_sel_hi:[1,0]
v_pk_add_f32 v[106:107], v[24:25], 1.0 op_sel_hi:[1,0]
v_pk_add_f32 v[104:105], v[48:49], 0 op_sel_hi:[1,0]
s_branch FM1_A0
FM1_F1:
s_add_u32 s51, s51, 1
v_readlane_b32 s52, v127, s51
v_pk_mul_f32 v[110:111], v[100:101], v[102:103] op_sel:[0,1] op_sel_hi:[1,0]
v_mul_f32 v114, v102, v103
v_add_f32 v112, v110, v111
v_pk_mul_f32 v[110:111], v[104:105], v[106:107] op_sel:[0,1] op_sel_hi:[1,0]
v_mul_f32 v115, v106, v107
v_add_f32 v113, v110, v111
v_pk_fma_f32 v[108:109], v[114:115], 4.0, v[108:109] op_sel_hi:[1,0,1]
v_rcp_f32 v114, v114
v_rcp_f32 v115, v115
s_nop 0
v_pk_mul_f32 v[112:113], v[112:113], v[114:115]
v_cvt_f64_f32 v[110:111], v112
v_cvt_f64_f32 v[114:115], v113
ds_add_f64 v126, v[110:111]
ds_add_f64 v126, v[114:115] offset:256
v_pk_fma_f32 v[108:109], v[112:113], 0, v[108:109] op_sel_hi:[1,0,1]
v_add_u32 v126, 528, v126
s_sub_u32 s49, s52, s50
v_pk_add_f32 v[102:103], v[18:19], 1.0 op_sel_hi:[1,0]
v_pk_add_f32 v[100:101], v[34:35], 0 op_sel_hi:[1,0]
v_pk_add_f32 v[106:107], v[26:27], 1.0 op_sel_hi:[1,0]
v_pk_add_f32 v[104:105], v[50:51], 0 op_sel_hi:[1,0]
s_branch FM1_A1
FM1_F2:
s_add_u32 s51, s51, 1
v_readlane_b32 s52, v127, s51
v_pk_mul_f32 v[110:111], v[100:101], v[102:103] op_sel:[0,1] op_sel_hi:[1,0]
v_mul_f32 v114, v102, v103
v_add_f32 v112, v110, v111
v_pk_mul_f32 v[110:111], v[104:105], v[106:107] op_sel:[0,1] op_sel_hi:[1,0]
v_mul_f32 v115, v106, v107
v_add_f32 v113, v110, v111
v_pk_fma_f32 v[108:109], v[114:115], 4.0, v[108:109] op_sel_hi:[1,0,1]
v_rcp_f32 v114, v114
v_rcp_f32 v115, v115
s_nop 0
v_pk_mul_f32 v[112:113], v[112:113], v[114:115]
v_cvt_f64_f32 v[110:111], v112
v_cvt_f64_f32 v[114:115], v113
ds_add_f64 v126, v[110:111]
ds_add_f64 v126, v[114:115] offset:256
v_pk_fma_f32 v[108:109], v[112:113], 0, v[108:109] op_sel_hi:[1,0,1]
v_add_u32 v126, 528, v126
s_sub_u32 s49, s52, s50
v_pk_add_f32 v[102:103], v[20:21], 1.0 op_sel_hi:[1,0]
v_pk_add_f32 v[100:101], v[36:37], 0 op_sel_hi:[1,0]
v_pk_add_f32 v[106:107], v[28:29], 1.0 op_sel_hi:[1,0]
v_pk_add_f32 v[104:105], v[52:53], 0 op_sel_hi:[1,0]
s_branch FM1_A2
FM1_F3:
s_add_u32 s51, s51, 1
v_readlane_b32 s52, v127, s51
v_pk_mul_f32 v[110:111], v[100:101], v[102:103] op_sel:[0,1] op_sel_hi:[1,0]
v_mul_f32 v114, v102, v103
v_add_f32 v112, v110, v111
v_pk_mul_f32 v[110:111], v[104:105], v[106:107] op_sel:[0,1] op_sel_hi:[1,0]
v_mul_f32 v115, v106, v107
v_add_f32 v113, v110, v111
v_pk_fma_f32 v[108:109], v[114:115], 4.0, v[108:109] op_sel_hi:[1,0,1]
v_rcp_f32 v114, v114
v_rcp_f32 v115, v115
s_nop 0
v_pk_mul_f32 v[112:113], v[112:113], v[114:115]
v_cvt_f64_f32 v[110:111], v112
v_cvt_f64_f32 v[114:115], v113
ds_add_f64 v126, v[110:111]
ds_add_f64 v126, v[114:115] offset:256
v_pk_fma_f32 v[108:109], v[112:113], 0, v[108:109] op_sel_hi:[1,0,1]
v_add_u32 v126, 528, v126
s_sub_u32 s49, s52, s50
v_pk_add_f32 v[102:103], v[22:23], 1.0 op_sel_hi:[1,0]
v_pk_add_f32 v[100:101], v[38:39], 0 op_sel_hi:[1,0]
v_pk_add_f32 v[106:107], v[30:31], 1.0 op_sel_hi:[1,0]
v_pk_add_f32 v[104:105], v[54:55], 0 op_sel_hi:[1,0]
s_branch FM1_J0
FM1_F4:
s_add_u32 s51, s51, 1
v_readlane_b32 s52, v127, s51
v_pk_mul_f32 v[110:111], v[100:101], v[102:103] op_sel:[0,1] op_sel_hi:[1,0]
v_mul_f32 v114, v102, v103
v_add_f32 v112, v110, v111
v_pk_mul_f32 v[110:111], v[104:105], v[106:107] op_sel:[0,1] op_sel_hi:[1,0]
v_mul_f32 v115, v106, v107
v_add_f32 v113, v110, v111
v_pk_fma_f32 v[108:109], v[114:115], 4.0, v[108:109] op_sel_hi:[1,0,1]
v_rcp_f32 v114, v114
v_rcp_f32 v115, v115
s_nop 0
v_pk_mul_f32 v[112:113], v[112:113], v[114:115]
v_cvt_f64_f32 v[110:111], v112
v_cvt_f64_f32 v[114:115], v113
ds_add_f64 v126, v[110:111]
ds_add_f64 v126, v[114:115] offset:256
v_pk_fma_f32 v[108:109], v[112:113], 0, v[108:109] op_sel_hi:[1,0,1]
v_add_u32 v126, 528, v126
s_sub_u32 s49, s52, s50
v_pk_add_f32 v[102:103], v[32:33], 1.0 op_sel_hi:[1,0]
v_pk_add_f32 v[100:101], v[40:41], 0 op_sel_hi:[1,0]
v_pk_add_f32 v[106:107], v[48:49], 1.0 op_sel_hi:[1,0]
v_pk_add_f32 v[104:105], v[56:57], 0 op_sel_hi:[1,0]
s_branch FM1_A4
FM1_F5:
s_add_u32 s51, s51, 1
v_readlane_b32 s52, v127, s51
v_pk_mul_f32 v[110:111], v[100:101], v[102:103] op_sel:[0,1] op_sel_hi:[1,0]
v_mul_f32 v114, v102, v103
v_add_f32 v112, v110, v111
v_pk_mul_f32 v[110:111], v[104:105], v[106:107] op_sel:[0,1] op_sel_hi:[1,0]
v_mul_f32 v115, v106, v107
v_add_f32 v113, v110, v111
v_pk_fma_f32 v[108:109], v[114:115], 4.0, v[108:109] op_sel_hi:[1,0,1]
v_rcp_f32 v114, v114
v_rcp_f32 v115, v115
s_nop 0
v_pk_mul_f32 v[112:113], v[112:113], v[114:115]
v_cvt_f64_f32 v[110:111], v112
v_cvt_f64_f32 v[114:115], v113
ds_add_f64 v126, v[110:111]
ds_add_f64 v126, v[114:115] offset:256
v_pk_fma_f32 v[108:109], v[112:113], 0, v[108:109] op_sel_hi:[1,0,1]
v_add_u32 v126, 528, v126
s_sub_u32 s49, s52, s50
v_pk_add_f32 v[102:103], v[34:35], 1.0 op_sel_hi:[1,0]
v_pk_add_f32 v[100:101], v[42:43], 0 op_sel_hi:[1,0]
v_pk_add_f32 v[106:107], v[50:51], 1.0 op_sel_hi:[1,0]
v_pk_add_f32 v[104:105], v[58:59], 0 op_sel_hi:[1,0]
s_branch FM1_A5
FM1_F6:
s_add_u32 s51, s51, 1
v_readlane_b32 s52, v127, s51
v_pk_mul_f32 v[110:111], v[100:101], v[102:103] op_sel:[0,1] op_sel_hi:[1,0]
v_mul_f32 v114, v102, v103
v_add_f32 v112, v110, v111
v_pk_mul_f32 v[110:111], v[104:105], v[106:107] op_sel:[0,1] op_sel_hi:[1,0]
v_mul_f32 v115, v106, v107
v_add_f32 v113, v110, v111
v_pk_fma_f32 v[108:109], v[114:115], 4.0, v[108:109] op_sel_hi:[1,0,1]
v_rcp_f32 v114, v114
v_rcp_f32 v115, v115
s_nop 0
v_pk_mul_f32 v[112:113], v[112:113], v[114:115]
v_cvt_f64_f32 v[110:111], v112
v_cvt_f64_f32 v[114:115], v113
ds_add_f64 v126, v[110:111]
ds_add_f64 v126, v[114:115] offset:256
v_pk_fma_f32 v[108:109], v[112:113], 0, v[108:109] op_sel_hi:[1,0,1]
v_add_u32 v126, 528, v126
s_sub_u32 s49, s52, s50
v_pk_add_f32 v[102:103], v[36:37], 1.0 op_sel_hi:[1,0]
v_pk_add_f32 v[100:101], v[44:45], 0 op_sel_hi:[1,0]
v_pk_add_f32 v[106:107], v[52:53], 1.0 op_sel_hi:[1,0]
v_pk_add_f32 v[104:105], v[60:61], 0 op_sel_hi:[1,0]
s_branch FM1_A6
FM1_F7:
s_add_u32 s51, s51, 1
v_readlane_b32 s52, v127, s51
v_pk_mul_f32 v[110:111], v[100:101], v[102:103] op_sel:[0,1] op_sel_hi:[1,0]
v_mul_f32 v114, v102, v103
v_add_f32 v112, v110, v111
v_pk_mul_f32 v[110:111], v[104:105], v[106:107] op_sel:[0,1] op_sel_hi:[1,0]
v_mul_f32 v115, v106, v107
v_add_f32 v113, v110, v111
v_pk_fma_f32 v[108:109], v[114:115], 4.0, v[108:109] op_sel_hi:[1,0,1]
v_rcp_f32 v114, v114
v_rcp_f32 v115, v115
s_nop 0
v_pk_mul_f32 v[112:113], v[112:113], v[114:115]
v_cvt_f64_f32 v[110:111], v112
v_cvt_f64_f32 v[114:115], v113
ds_add_f64 v126, v[110:111]
ds_add_f64 v126, v[114:115] offset:256
v_pk_fma_f32 v[108:109], v[112:113], 0, v[108:109] op_sel_hi:[1,0,1]
v_add_u32 v126, 528, v126
s_sub_u32 s49, s52, s50
v_pk_add_f32 v[102:103], v[38:39], 1.0 op_sel_hi:[1,0]
v_pk_add_f32 v[100:101], v[46:47], 0 op_sel_hi:[1,0]
v_pk_add_f32 v[106:107], v[54:55], 1.0 op_sel_hi:[1,0]
v_pk_add_f32 v[104:105], v[62:63], 0 op_sel_hi:[1,0]
s_branch FM1_J1
FD0_C0:
s_cmp_eq_u32 s49, 0
s_cbranch_scc1 FD0_F0
v_pk_fma_f32 v[100:101], v[100:101], v[48:49], v[100:101]
v_pk_fma_f32 v[104:105], v[104:105], v[56:57], v[104:105]
v_pk_fma_f32 v[100:101], v[0:1], v[102:103], v[100:101]
v_pk_fma_f32 v[104:105], v[16:17], v[106:107], v[104:105]
v_pk_fma_f32 v[102:103], v[102:103], v[48:49], v[102:103]
v_pk_fma_f32 v[106:107], v[106:107], v[56:57], v[106:107]
FD0_A0:
s_cmp_eq_u32 s49, 1
s_cbranch_scc1 FD0_F1
v_pk_fma_f32 v[100:101], v[100:101], v[50:51], v[100:101]
v_pk_fma_f32 v[104:105], v[104:105], v[58:59], v[104:105]
v_pk_fma_f32 v[100:101], v[2:3], v[102:103], v[100:101]
v_pk_fma_f32 v[104:105], v[18:19], v[106:107], v[104:105]
v_pk_fma_f32 v[102:103], v[102:103], v[50:51], v[102:103]
v_pk_fma_f32 v[106:107], v[106:107], v[58:59], v[106:107]
FD0_A1:
s_cmp_eq_u32 s49, 2
s_cbranch_scc1 FD0_F2
v_pk_fma_f32 v[100:101], v[100:101], v[52:53], v[100:101]
v_pk_fma_f32 v[104:105], v[104:105], v[60:61], v[104:105]
v_pk_fma_f32 v[100:101], v[4:5], v[102:103], v[100:101]
v_pk_fma_f32 v[104:105], v[20:21], v[106:107], v[104:105]
v_pk_fma_f32 v[102:103], v[102:103], v[52:53], v[102:103]
v_pk_fma_f32 v[106:107], v[106:107], v[60:61], v[106:107]
FD0_A2:
s_cmp_eq_u32 s49, 3
s_cbranch_scc1 FD0_F3
v_pk_fma_f32 v[100:101], v[100:101], v[54:55], v[100:101]
v_pk_fma_f32 v[104:105], v[104:105], v[62:63], v[104:105]
v_pk_fma_f32 v[100:101], v[6:7], v[102:103], v[100:101]
v_pk_fma_f32 v[104:105], v[22:23], v[106:107], v[104:105]
v_pk_fma_f32 v[102:103], v[102:103], v[54:55], v[102:103]
v_pk_fma_f32 v[106:107], v[106:107], v[62:63], v[106:107]
s_branch FD0_J0
FD0_C1:
s_cmp_eq_u32 s49, 4
s_cbranch_scc1 FD0_F4
v_pk_fma_f32 v[100:101], v[100:101], v[0:1], v[100:101]
v_pk_fma_f32 v[104:105], v[104:105], v[16:17], v[104:105]
v_pk_fma_f32 v[100:101], v[8:9], v[102:103], v[100:101]
v_pk_fma_f32 v[104:105], v[24:25], v[106:107], v[104:105]
v_pk_fma_f32 v[102:103], v[102:103], v[0:1], v[102:103]
v_pk_fma_f32 v[106:107], v[106:107], v[16:17], v[106:107]
FD0_A4:
s_cmp_eq_u32 s49, 5
s_cbranch_scc1 FD0_F5
v_pk_fma_f32 v[100:101], v[100:101], v[2:3], v[100:101]
v_pk_fma_f32 v[104:105], v[104:105], v[18:19], v[104:105]
v_pk_fma_f32 v[100:101], v[10:11], v[102:103], v[100:101]
v_pk_fma_f32 v[104:105], v[26:27], v[106:107], v[104:105]
v_pk_fma_f32 v[102:103], v[102:103], v[2:3], v[102:103]
v_pk_fma_f32 v[106:107], v[106:107], v[18:19], v[106:107]
FD0_A5:
s_cmp_eq_u32 s49, 6
s_cbranch_scc1 FD0_F6
v_pk_fma_f32 v[100:101], v[100:101], v[4:5], v[100:101]
v_pk_fma_f32 v[104:105], v[104:105], v[20:21], v[104:105]
v_pk_fma_f32 v[100:101], v[12:13], v[102:103], v[100:101]
v_pk_fma_f32 v[104:105], v[28:29], v[106:107], v[104:105]
v_pk_fma_f32 v[102:103], v[102:103], v[4:5], v[102:103]
v_pk_fma_f32 v[106:107], v[106:107], v[20:21], v[106:107]
FD0_A6:
s_cmp_eq_u32 s49, 7
s_cbranch_scc1 FD0_F7
v_pk_fma_f32 v[100:101], v[100:101], v[6:7], v[100:101]
v_pk_fma_f32 v[104:105], v[104:105], v[22:23], v[104:105]
v_pk_fma_f32 v[100:101], v[14:15], v[102:103], v[100:101]
v_pk_fma_f32 v[104:105], v[30:31], v[106:107], v[104:105]
v_pk_fma_f32 v[102:103], v[102:103], v[6:7], v[102:103]
v_pk_fma_f32 v[106:107], v[106:107], v[22:23], v[106:107]
s_branch FD0_J1
FD0_F0:
s_add_u32 s51, s51, 1
v_readlane_b32 s52, v127, s51
v_pk_mul_f32 v[110:111], v[100:101], v[102:103] op_sel:[0,1] op_sel_hi:[1,0]
v_mul_f32 v114, v102, v103
v_add_f32 v112, v110, v111
v_pk_mul_f32 v[110:111], v[104:105], v[106:107] op_sel:[0,1] op_sel_hi:[1,0]
v_mul_f32 v115, v106, v107
v_add_f32 v113, v110, v111
v_pk_fma_f32 v[108:109], v[114:115], 4.0, v[108:109] op_sel_hi:[1,0,1]
v_rcp_f32 v114, v114
v_rcp_f32 v115, v115
s_nop 0
v_pk_mul_f32 v[112:113], v[112:113], v[114:115]
v_cvt_f64_f32 v[110:111], v112
v_cvt_f64_f32 v[114:115], v113
ds_add_f64 v126, v[110:111]
ds_add_f64 v126, v[114:115] offset:256
v_pk_fma_f32 v[108:109], v[112:113], 0, v[108:109] op_sel_hi:[1,0,1]
v_add_u32 v126, 528, v126
s_sub_u32 s49, s52, s50
v_pk_add_f32 v[102:103], v[48:49], 1.0 op_sel_hi:[1,0]
v_pk_add_f32 v[100:101], v[0:1], 0 op_sel_hi:[1,0]
v_pk_add_f32 v[106:107], v[56:57], 1.0 op_sel_hi:[1,0]
v_pk_add_f32 v[104:105], v[16:17], 0 op_sel_hi:[1,0]
s_branch FD0_A0
FD0_F1:
s_add_u32 s51, s51, 1
v_readlane_b32 s52, v127, s51
v_pk_mul_f32 v[110:111], v[100:101], v[102:103] op_sel:[0,1] op_sel_hi:[1,0]
v_mul_f32 v114, v102, v103
v_add_f32 v112, v110, v111
v_pk_mul_f32 v[110:111], v[104:105], v[106:107] op_sel:[0,1] op_sel_hi:[1,0]
v_mul_f32 v115, v106, v107
v_add_f32 v113, v110, v111
v_pk_fma_f32 v[108:109], v[114:115], 4.0, v[108:109] op_sel_hi:[1,0,1]
v_rcp_f32 v114, v114
v_rcp_f32 v115, v115
s_nop 0
v_pk_mul_f32 v[112:113], v[112:113], v[114:115]
v_cvt_f64_f32 v[110:111], v112
v_cvt_f64_f32 v[114:115], v113
ds_add_f64 v126, v[110:111]
ds_add_f64 v126, v[114:115] offset:256
v_pk_fma_f32 v[108:109], v[112:113], 0, v[108:109] op_sel_hi:[1,0,1]
v_add_u32 v126, 528, v126
s_sub_u32 s49, s52, s50
v_pk_add_f32 v[102:103], v[50:51], 1.0 op_sel_hi:[1,0]
v_pk_add_f32 v[100:101], v[2:3], 0 op_sel_hi:[1,0]
v_pk_add_f32 v[106:107], v[58:59], 1.0 op_sel_hi:[1,0]
v_pk_add_f32 v[104:105], v[18:19], 0 op_sel_hi:[1,0]
s_branch FD0_A1
FD0_F2:
s_add_u32 s51, s51, 1
v_readlane_b32 s52, v127, s51
v_pk_mul_f32 v[110:111], v[100:101], v[102:103] op_sel:[0,1] op_sel_hi:[1,0]
v_mul_f32 v114, v102, v103
v_add_f32 v112, v110, v111
v_pk_mul_f32 v[110:111], v[104:105], v[106:107] op_sel:[0,1] op_sel_hi:[1,0]
v_mul_f32 v115, v106, v107
v_add_f32 v113, v110, v111
v_pk_fma_f32 v[108:109], v[114:115], 4.0, v[108:109] op_sel_hi:[1,0,1]
v_rcp_f32 v114, v114
v_rcp_f32 v115, v115
s_nop 0
v_pk_mul_f32 v[112:113], v[112:113], v[114:115]
v_cvt_f64_f32 v[110:111], v112
v_cvt_f64_f32 v[114:115], v113
ds_add_f64 v126, v[110:111]
ds_add_f64 v126, v[114:115] offset:256
v_pk_fma_f32 v[108:109], v[112:113], 0, v[108:109] op_sel_hi:[1,0,1]
v_add_u32 v126, 528, v126
s_sub_u32 s49, s52, s50
v_pk_add_f32 v[102:103], v[52:53], 1.0 op_sel_hi:[1,0]
v_pk_add_f32 v[100:101], v[4:5], 0 op_sel_hi:[1,0]
v_pk_add_f32 v[106:107], v[60:61], 1.0 op_sel_hi:[1,0]
v_pk_add_f32 v[104:105], v[20:21], 0 op_sel_hi:[1,0]
s_branch FD0_A2
FD0_F3:
s_add_u32 s51, s51, 1
v_readlane_b32 s52, v127, s51
v_pk_mul_f32 v[110:111], v[100:101], v[102:103] op_sel:[0,1] op_sel_hi:[1,0]
v_mul_f32 v114, v102, v103
v_add_f32 v112, v110, v111
v_pk_mul_f32 v[110:111], v[104:105], v[106:107] op_sel:[0,1] op_sel_hi:[1,0]
v_mul_f32 v115, v106, v107
v_add_f32 v113, v110, v111
v_pk_fma_f32 v[108:109], v[114:115], 4.0, v[108:109] op_sel_hi:[1,0,1]
v_rcp_f32 v114, v114
v_rcp_f32 v115, v115
s_nop 0
v_pk_mul_f32 v[112:113], v[112:113], v[114:115]
v_cvt_f64_f32 v[110:111], v112
v_cvt_f64_f32 v[114:115], v113
ds_add_f64 v126, v[110:111]
ds_add_f64 v126, v[114:115] offset:256
v_pk_fma_f32 v[108:109], v[112:113], 0, v[108:109] op_sel_hi:[1,0,1]
v_add_u32 v126, 528, v126
s_sub_u32 s49, s52, s50
v_pk_add_f32 v[102:103], v[54:55], 1.0 op_sel_hi:[1,0]
v_pk_add_f32 v[100:101], v[6:7], 0 op_sel_hi:[1,0]
v_pk_add_f32 v[106:107], v[62:63], 1.0 op_sel_hi:[1,0]
v_pk_add_f32 v[104:105], v[22:23], 0 op_sel_hi:[1,0]
s_branch FD0_J0
FD0_F4:
s_add_u32 s51, s51, 1
v_readlane_b32 s52, v127, s51
v_pk_mul_f32 v[110:111], v[100:101], v[102:103] op_sel:[0,1] op_sel_hi:[1,0]
v_mul_f32 v114, v102, v103
v_add_f32 v112, v110, v111
v_pk_mul_f32 v[110:111], v[104:105], v[106:107] op_sel:[0,1] op_sel_hi:[1,0]
v_mul_f32 v115, v106, v107
v_add_f32 v113, v110, v111
v_pk_fma_f32 v[108:109], v[114:115], 4.0, v[108:109] op_sel_hi:[1,0,1]
v_rcp_f32 v114, v114
v_rcp_f32 v115, v115
s_nop 0
v_pk_mul_f32 v[112:113], v[112:113], v[114:115]
v_cvt_f64_f32 v[110:111], v112
v_cvt_f64_f32 v[114:115], v113
ds_add_f64 v126, v[110:111]
ds_add_f64 v126, v[114:115] offset:256
v_pk_fma_f32 v[108:109], v[112:113], 0, v[108:109] op_sel_hi:[1,0,1]
v_add_u32 v126, 528, v126
s_sub_u32 s49, s52, s50
v_pk_add_f32 v[102:103], v[0:1], 1.0 op_sel_hi:[1,0]
v_pk_add_f32 v[100:101], v[8:9], 0 op_sel_hi:[1,0]
v_pk_add_f32 v[106:107], v[16:17], 1.0 op_sel_hi:[1,0]
v_pk_add_f32 v[104:105], v[24:25], 0 op_sel_hi:[1,0]
s_branch FD0_A4
FD0_F5:
s_add_u32 s51, s51, 1
v_readlane_b32 s52, v127, s51
v_pk_mul_f32 v[110:111], v[100:101], v[102:103] op_sel:[0,1] op_sel_hi:[1,0]
v_mul_f32 v114, v102, v103
v_add_f32 v112, v110, v111
v_pk_mul_f32 v[110:111], v[104:105], v[106:107] op_sel:[0,1] op_sel_hi:[1,0]
v_mul_f32 v115, v106, v107
v_add_f32 v113, v110, v111
v_pk_fma_f32 v[108:109], v[114:115], 4.0, v[108:109] op_sel_hi:[1,0,1]
v_rcp_f32 v114, v114
v_rcp_f32 v115, v115
s_nop 0
v_pk_mul_f32 v[112:113], v[112:113], v[114:115]
v_cvt_f64_f32 v[110:111], v112
v_cvt_f64_f32 v[114:115], v113
ds_add_f64 v126, v[110:111]
ds_add_f64 v126, v[114:115] offset:256
v_pk_fma_f32 v[108:109], v[112:113], 0, v[108:109] op_sel_hi:[1,0,1]
v_add_u32 v126, 528, v126
s_sub_u32 s49, s52, s50
v_pk_add_f32 v[102:103], v[2:3], 1.0 op_sel_hi:[1,0]
v_pk_add_f32 v[100:101], v[10:11], 0 op_sel_hi:[1,0]
v_pk_add_f32 v[106:107], v[18:19], 1.0 op_sel_hi:[1,0]
v_pk_add_f32 v[104:105], v[26:27], 0 op_sel_hi:[1,0]
s_branch FD0_A5
FD0_F6:
s_add_u32 s51, s51, 1
v_readlane_b32 s52, v127, s51
v_pk_mul_f32 v[110:111], v[100:101], v[102:103] op_sel:[0,1] op_sel_hi:[1,0]
v_mul_f32 v114, v102, v103
v_add_f32 v112, v110, v111
v_pk_mul_f32 v[110:111], v[104:105], v[106:107] op_sel:[0,1] op_sel_hi:[1,0]
v_mul_f32 v115, v106, v107
v_add_f32 v113, v110, v111
v_pk_fma_f32 v[108:109], v[114:115], 4.0, v[108:109] op_sel_hi:[1,0,1]
v_rcp_f32 v114, v114
v_rcp_f32 v115, v115
s_nop 0
v_pk_mul_f32 v[112:113], v[112:113], v[114:115]
v_cvt_f64_f32 v[110:111], v112
v_cvt_f64_f32 v[114:115], v113
ds_add_f64 v126, v[110:111]
ds_add_f64 v126, v[114:115] offset:256
v_pk_fma_f32 v[108:109], v[112:113], 0, v[108:109] op_sel_hi:[1,0,1]
v_add_u32 v126, 528, v126
s_sub_u32 s49, s52, s50
v_pk_add_f32 v[102:103], v[4:5], 1.0 op_sel_hi:[1,0]
v_pk_add_f32 v[100:101], v[12:13], 0 op_sel_hi:[1,0]
v_pk_add_f32 v[106:107], v[20:21], 1.0 op_sel_hi:[1,0]
v_pk_add_f32 v[104:105], v[28:29], 0 op_sel_hi:[1,0]
s_branch FD0_A6
FD0_F7:
s_add_u32 s51, s51, 1
v_readlane_b32 s52, v127, s51
v_pk_mul_f32 v[110:111], v[100:101], v[102:103] op_sel:[0,1] op_sel_hi:[1,0]
v_mul_f32 v114, v102, v103
v_add_f32 v112, v110, v111
v_pk_mul_f32 v[110:111], v[104:105], v[106:107] op_sel:[0,1] op_sel_hi:[1,0]
v_mul_f32 v115, v106, v107
v_add_f32 v113, v110, v111
v_pk_fma_f32 v[108:109], v[114:115], 4.0, v[108:109] op_sel_hi:[1,0,1]
v_rcp_f32 v114, v114
v_rcp_f32 v115, v115
s_nop 0
v_pk_mul_f32 v[112:113], v[112:113], v[114:115]
v_cvt_f64_f32 v[110:111], v112
v_cvt_f64_f32 v[114:115], v113
ds_add_f64 v126, v[110:111]
ds_add_f64 v126, v[114:115] offset:256
v_pk_fma_f32 v[108:109], v[112:113], 0, v[108:109] op_sel_hi:[1,0,1]
v_add_u32 v126, 528, v126
s_sub_u32 s49, s52, s50
v_pk_add_f32 v[102:103], v[6:7], 1.0 op_sel_hi:[1,0]
v_pk_add_f32 v[100:101], v[14:15], 0 op_sel_hi:[1,0]
v_pk_add_f32 v[106:107], v[22:23], 1.0 op_sel_hi:[1,0]
v_pk_add_f32 v[104:105], v[30:31], 0 op_sel_hi:[1,0]
s_branch FD0_J1
FE1_C0:
s_cmp_eq_u32 s49, 0
s_cbranch_scc1 FE1_F0
v_pk_fma_f32 v[100:101], v[100:101], v[16:17], v[100:101]
v_pk_fma_f32 v[104:105], v[104:105], v[24:25], v[104:105]
v_pk_fma_f32 v[100:101], v[32:33], v[102:103], v[100:101]
v_pk_fma_f32 v[104:105], v[48:49], v[106:107], v[104:105]
v_pk_fma_f32 v[102:103], v[102:103], v[16:17], v[102:103]
v_pk_fma_f32 v[106:107], v[106:107], v[24:25], v[106:107]
FE1_A0:
s_cmp_eq_u32 s49, 1
s_cbranch_scc1 FE1_F1
v_pk_fma_f32 v[100:101], v[100:101], v[18:19], v[100:101]
v_pk_fma_f32 v[104:105], v[104:105], v[26:27], v[104:105]
v_pk_fma_f32 v[100:101], v[34:35], v[102:103], v[100:101]
v_pk_fma_f32 v[104:105], v[50:51], v[106:107], v[104:105]
v_pk_fma_f32 v[102:103], v[102:103], v[18:19], v[102:103]
v_pk_fma_f32 v[106:107], v[106:107], v[26:27], v[106:107]
FE1_A1:
s_cmp_eq_u32 s49, 2
s_cbranch_scc1 FE1_F2
v_pk_fma_f32 v[100:101], v[100:101], v[20:21], v[100:101]
v_pk_fma_f32 v[104:105], v[104:105], v[28:29], v[104:105]
v_pk_fma_f32 v[100:101], v[36:37], v[102:103], v[100:101]
v_pk_fma_f32 v[104:105], v[52:53], v[106:107], v[104:105]
v_pk_fma_f32 v[102:103], v[102:103], v[20:21], v[102:103]
v_pk_fma_f32 v[106:107], v[106:107], v[28:29], v[106:107]
FE1_A2:
s_cmp_eq_u32 s49, 3
s_cbranch_scc1 FE1_F3
v_pk_fma_f32 v[100:101], v[100:101], v[22:23], v[100:101]
v_pk_fma_f32 v[104:105], v[104:105], v[30:31], v[104:105]
v_pk_fma_f32 v[100:101], v[38:39], v[102:103], v[100:101]
v_pk_fma_f32 v[104:105], v[54:55], v[106:107], v[104:105]
v_pk_fma_f32 v[102:103], v[102:103], v[22:23], v[102:103]
v_pk_fma_f32 v[106:107], v[106:107], v[30:31], v[106:107]
s_branch FE1_J0
FE1_C1:
s_cmp_eq_u32 s49, 4
s_cbranch_scc1 FE1_F4
v_pk_fma_f32 v[100:101], v[100:101], v[32:33], v[100:101]
v_pk_fma_f32 v[104:105], v[104:105], v[48:49], v[104:105]
v_pk_fma_f32 v[100:101], v[40:41], v[102:103], v[100:101]
v_pk_fma_f32 v[104:105], v[56:57], v[106:107], v[104:105]
v_pk_fma_f32 v[102:103], v[102:103], v[32:33], v[102:103]
v_pk_fma_f32 v[106:107], v[106:107], v[48:49], v[106:107]
FE1_A4:
s_cmp_eq_u32 s49, 5
s_cbranch_scc1 FE1_F5
v_pk_fma_f32 v[100:101], v[100:101], v[34:35], v[100:101]
v_pk_fma_f32 v[104:105], v[104:105], v[50:51], v[104:105]
v_pk_fma_f32 v[100:101], v[42:43], v[102:103], v[100:101]
v_pk_fma_f32 v[104:105], v[58:59], v[106:107], v[104:105]
v_pk_fma_f32 v[102:103], v[102:103], v[34:35], v[102:103]
v_pk_fma_f32 v[106:107], v[106:107], v[50:51], v[106:107]
FE1_A5:
s_cmp_eq_u32 s49, 6
s_cbranch_scc1 FE1_F6
v_pk_fma_f32 v[100:101], v[100:101], v[36:37], v[100:101]
v_pk_fma_f32 v[104:105], v[104:105], v[52:53], v[104:105]
v_pk_fma_f32 v[100:101], v[44:45], v[102:103], v[100:101]
v_pk_fma_f32 v[104:105], v[60:61], v[106:107], v[104:105]
v_pk_fma_f32 v[102:103], v[102:103], v[36:37], v[102:103]
v_pk_fma_f32 v[106:107], v[106:107], v[52:53], v[106:107]
FE1_A6:
s_cmp_eq_u32 s49, 7
s_cbranch_scc1 FE1_F7
v_pk_fma_f32 v[100:101], v[100:101], v[38:39], v[100:101]
v_pk_fma_f32 v[104:105], v[104:105], v[54:55], v[104:105]
v_pk_fma_f32 v[100:101], v[46:47], v[102:103], v[100:101]
v_pk_fma_f32 v[104:105], v[62:63], v[106:107], v[104:105]
v_pk_fma_f32 v[102:103], v[102:103], v[38:39], v[102:103]
v_pk_fma_f32 v[106:107], v[106:107], v[54:55], v[106:107]
s_branch FE1_J1
FE1_F0:
s_add_u32 s51, s51, 1
v_readlane_b32 s52, v127, s51
v_pk_mul_f32 v[110:111], v[100:101], v[102:103] op_sel:[0,1] op_sel_hi:[1,0]
v_mul_f32 v114, v102, v103
v_add_f32 v112, v110, v111
v_pk_mul_f32 v[110:111], v[104:105], v[106:107] op_sel:[0,1] op_sel_hi:[1,0]
v_mul_f32 v115, v106, v107
v_add_f32 v113, v110, v111
v_pk_fma_f32 v[108:109], v[114:115], 4.0, v[108:109] op_sel_hi:[1,0,1]
v_rcp_f32 v114, v114
v_rcp_f32 v115, v115
s_nop 0
v_pk_mul_f32 v[112:113], v[112:113], v[114:115]
v_cvt_f64_f32 v[110:111], v112
v_cvt_f64_f32 v[114:115], v113
ds_add_f64 v126, v[110:111]
ds_add_f64 v126, v[114:115] offset:256
v_pk_fma_f32 v[108:109], v[112:113], 0, v[108:109] op_sel_hi:[1,0,1]
v_add_u32 v126, 528, v126
s_sub_u32 s49, s52, s50
v_pk_add_f32 v[102:103], v[16:17], 1.0 op_sel_hi:[1,0]
v_pk_add_f32 v[100:101], v[32:33], 0 op_sel_hi:[1,0]
v_pk_add_f32 v[106:107], v[24:25], 1.0 op_sel_hi:[1,0]
v_pk_add_f32 v[104:105], v[48:49], 0 op_sel_hi:[1,0]
s_branch FE1_A0
FE1_F1:
s_add_u32 s51, s51, 1
v_readlane_b32 s52, v127, s51
v_pk_mul_f32 v[110:111], v[100:101], v[102:103] op_sel:[0,1] op_sel_hi:[1,0]
v_mul_f32 v114, v102, v103
v_add_f32 v112, v110, v111
v_pk_mul_f32 v[110:111], v[104:105], v[106:107] op_sel:[0,1] op_sel_hi:[1,0]
v_mul_f32 v115, v106, v107
v_add_f32 v113, v110, v111
v_pk_fma_f32 v[108:109], v[114:115], 4.0, v[108:109] op_sel_hi:[1,0,1]
v_rcp_f32 v114, v114
v_rcp_f32 v115, v115
s_nop 0
v_pk_mul_f32 v[112:113], v[112:113], v[114:115]
v_cvt_f64_f32 v[110:111], v112
v_cvt_f64_f32 v[114:115], v113
ds_add_f64 v126, v[110:111]
ds_add_f64 v126, v[114:115] offset:256
v_pk_fma_f32 v[108:109], v[112:113], 0, v[108:109] op_sel_hi:[1,0,1]
v_add_u32 v126, 528, v126
s_sub_u32 s49, s52, s50
v_pk_add_f32 v[102:103], v[18:19], 1.0 op_sel_hi:[1,0]
v_pk_add_f32 v[100:101], v[34:35], 0 op_sel_hi:[1,0]
v_pk_add_f32 v[106:107], v[26:27], 1.0 op_sel_hi:[1,0]
v_pk_add_f32 v[104:105], v[50:51], 0 op_sel_hi:[1,0]
s_branch FE1_A1
FE1_F2:
s_add_u32 s51, s51, 1
v_readlane_b32 s52, v127, s51
v_pk_mul_f32 v[110:111], v[100:101], v[102:103] op_sel:[0,1] op_sel_hi:[1,0]
v_mul_f32 v114, v102, v103
v_add_f32 v112, v110, v111
v_pk_mul_f32 v[110:111], v[104:105], v[106:107] op_sel:[0,1] op_sel_hi:[1,0]
v_mul_f32 v115, v106, v107
v_add_f32 v113, v110, v111
v_pk_fma_f32 v[108:109], v[114:115], 4.0, v[108:109] op_sel_hi:[1,0,1]
v_rcp_f32 v114, v114
v_rcp_f32 v115, v115
s_nop 0
v_pk_mul_f32 v[112:113], v[112:113], v[114:115]
v_cvt_f64_f32 v[110:111], v112
v_cvt_f64_f32 v[114:115], v113
ds_add_f64 v126, v[110:111]
ds_add_f64 v126, v[114:115] offset:256
v_pk_fma_f32 v[108:109], v[112:113], 0, v[108:109] op_sel_hi:[1,0,1]
v_add_u32 v126, 528, v126
s_sub_u32 s49, s52, s50
v_pk_add_f32 v[102:103], v[20:21], 1.0 op_sel_hi:[1,0]
v_pk_add_f32 v[100:101], v[36:37], 0 op_sel_hi:[1,0]
v_pk_add_f32 v[106:107], v[28:29], 1.0 op_sel_hi:[1,0]
v_pk_add_f32 v[104:105], v[52:53], 0 op_sel_hi:[1,0]
s_branch FE1_A2
FE1_F3:
s_add_u32 s51, s51, 1
v_readlane_b32 s52, v127, s51
v_pk_mul_f32 v[110:111], v[100:101], v[102:103] op_sel:[0,1] op_sel_hi:[1,0]
v_mul_f32 v114, v102, v103
v_add_f32 v112, v110, v111
v_pk_mul_f32 v[110:111], v[104:105], v[106:107] op_sel:[0,1] op_sel_hi:[1,0]
v_mul_f32 v115, v106, v107
v_add_f32 v113, v110, v111
v_pk_fma_f32 v[108:109], v[114:115], 4.0, v[108:109] op_sel_hi:[1,0,1]
v_rcp_f32 v114, v114
v_rcp_f32 v115, v115
s_nop 0
v_pk_mul_f32 v[112:113], v[112:113], v[114:115]
v_cvt_f64_f32 v[110:111], v112
v_cvt_f64_f32 v[114:115], v113
ds_add_f64 v126, v[110:111]
ds_add_f64 v126, v[114:115] offset:256
v_pk_fma_f32 v[108:109], v[112:113], 0, v[108:109] op_sel_hi:[1,0,1]
v_add_u32 v126, 528, v126
s_sub_u32 s49, s52, s50
v_pk_add_f32 v[102:103], v[22:23], 1.0 op_sel_hi:[1,0]
v_pk_add_f32 v[100:101], v[38:39], 0 op_sel_hi:[1,0]
v_pk_add_f32 v[106:107], v[30:31], 1.0 op_sel_hi:[1,0]
v_pk_add_f32 v[104:105], v[54:55], 0 op_sel_hi:[1,0]
s_branch FE1_J0
FE1_F4:
s_add_u32 s51, s51, 1
v_readlane_b32 s52, v127, s51
v_pk_mul_f32 v[110:111], v[100:101], v[102:103] op_sel:[0,1] op_sel_hi:[1,0]
v_mul_f32 v114, v102, v103
v_add_f32 v112, v110, v111
v_pk_mul_f32 v[110:111], v[104:105], v[106:107] op_sel:[0,1] op_sel_hi:[1,0]
v_mul_f32 v115, v106, v107
v_add_f32 v113, v110, v111
v_pk_fma_f32 v[108:109], v[114:115], 4.0, v[108:109] op_sel_hi:[1,0,1]
v_rcp_f32 v114, v114
v_rcp_f32 v115, v115
s_nop 0
v_pk_mul_f32 v[112:113], v[112:113], v[114:115]
v_cvt_f64_f32 v[110:111], v112
v_cvt_f64_f32 v[114:115], v113
ds_add_f64 v126, v[110:111]
ds_add_f64 v126, v[114:115] offset:256
v_pk_fma_f32 v[108:109], v[112:113], 0, v[108:109] op_sel_hi:[1,0,1]
v_add_u32 v126, 528, v126
s_sub_u32 s49, s52, s50
v_pk_add_f32 v[102:103], v[32:33], 1.0 op_sel_hi:[1,0]
v_pk_add_f32 v[100:101], v[40:41], 0 op_sel_hi:[1,0]
v_pk_add_f32 v[106:107], v[48:49], 1.0 op_sel_hi:[1,0]
v_pk_add_f32 v[104:105], v[56:57], 0 op_sel_hi:[1,0]
s_branch FE1_A4
FE1_F5:
s_add_u32 s51, s51, 1
v_readlane_b32 s52, v127, s51
v_pk_mul_f32 v[110:111], v[100:101], v[102:103] op_sel:[0,1] op_sel_hi:[1,0]
v_mul_f32 v114, v102, v103
v_add_f32 v112, v110, v111
v_pk_mul_f32 v[110:111], v[104:105], v[106:107] op_sel:[0,1] op_sel_hi:[1,0]
v_mul_f32 v115, v106, v107
v_add_f32 v113, v110, v111
v_pk_fma_f32 v[108:109], v[114:115], 4.0, v[108:109] op_sel_hi:[1,0,1]
v_rcp_f32 v114, v114
v_rcp_f32 v115, v115
s_nop 0
v_pk_mul_f32 v[112:113], v[112:113], v[114:115]
v_cvt_f64_f32 v[110:111], v112
v_cvt_f64_f32 v[114:115], v113
ds_add_f64 v126, v[110:111]
ds_add_f64 v126, v[114:115] offset:256
v_pk_fma_f32 v[108:109], v[112:113], 0, v[108:109] op_sel_hi:[1,0,1]
v_add_u32 v126, 528, v126
s_sub_u32 s49, s52, s50
v_pk_add_f32 v[102:103], v[34:35], 1.0 op_sel_hi:[1,0]
v_pk_add_f32 v[100:101], v[42:43], 0 op_sel_hi:[1,0]
v_pk_add_f32 v[106:107], v[50:51], 1.0 op_sel_hi:[1,0]
v_pk_add_f32 v[104:105], v[58:59], 0 op_sel_hi:[1,0]
s_branch FE1_A5
FE1_F6:
s_add_u32 s51, s51, 1
v_readlane_b32 s52, v127, s51
v_pk_mul_f32 v[110:111], v[100:101], v[102:103] op_sel:[0,1] op_sel_hi:[1,0]
v_mul_f32 v114, v102, v103
v_add_f32 v112, v110, v111
v_pk_mul_f32 v[110:111], v[104:105], v[106:107] op_sel:[0,1] op_sel_hi:[1,0]
v_mul_f32 v115, v106, v107
v_add_f32 v113, v110, v111
v_pk_fma_f32 v[108:109], v[114:115], 4.0, v[108:109] op_sel_hi:[1,0,1]
v_rcp_f32 v114, v114
v_rcp_f32 v115, v115
s_nop 0
v_pk_mul_f32 v[112:113], v[112:113], v[114:115]
v_cvt_f64_f32 v[110:111], v112
v_cvt_f64_f32 v[114:115], v113
ds_add_f64 v126, v[110:111]
ds_add_f64 v126, v[114:115] offset:256
v_pk_fma_f32 v[108:109], v[112:113], 0, v[108:109] op_sel_hi:[1,0,1]
v_add_u32 v126, 528, v126
s_sub_u32 s49, s52, s50
v_pk_add_f32 v[102:103], v[36:37], 1.0 op_sel_hi:[1,0]
v_pk_add_f32 v[100:101], v[44:45], 0 op_sel_hi:[1,0]
v_pk_add_f32 v[106:107], v[52:53], 1.0 op_sel_hi:[1,0]
v_pk_add_f32 v[104:105], v[60:61], 0 op_sel_hi:[1,0]
s_branch FE1_A6
FE1_F7:
s_add_u32 s51, s51, 1
v_readlane_b32 s52, v127, s51
v_pk_mul_f32 v[110:111], v[100:101], v[102:103] op_sel:[0,1] op_sel_hi:[1,0]
v_mul_f32 v114, v102, v103
v_add_f32 v112, v110, v111
v_pk_mul_f32 v[110:111], v[104:105], v[106:107] op_sel:[0,1] op_sel_hi:[1,0]
v_mul_f32 v115, v106, v107
v_add_f32 v113, v110, v111
v_pk_fma_f32 v[108:109], v[114:115], 4.0, v[108:109] op_sel_hi:[1,0,1]
v_rcp_f32 v114, v114
v_rcp_f32 v115, v115
s_nop 0
v_pk_mul_f32 v[112:113], v[112:113], v[114:115]
v_cvt_f64_f32 v[110:111], v112
v_cvt_f64_f32 v[114:115], v113
ds_add_f64 v126, v[110:111]
ds_add_f64 v126, v[114:115] offset:256
v_pk_fma_f32 v[108:109], v[112:113], 0, v[108:109] op_sel_hi:[1,0,1]
v_add_u32 v126, 528, v126
s_sub_u32 s49, s52, s50
v_pk_add_f32 v[102:103], v[38:39], 1.0 op_sel_hi:[1,0]
v_pk_add_f32 v[100:101], v[46:47], 0 op_sel_hi:[1,0]
v_pk_add_f32 v[106:107], v[54:55], 1.0 op_sel_hi:[1,0]
v_pk_add_f32 v[104:105], v[62:63], 0 op_sel_hi:[1,0]
s_branch FE1_J1
FL0_C0:
s_cmp_eq_u32 s49, 0
s_cbranch_scc1 FL0_F0
v_pk_fma_f32 v[100:101], v[100:101], v[48:49], v[100:101]
v_pk_fma_f32 v[104:105], v[104:105], v[56:57], v[104:105]
v_pk_fma_f32 v[100:101], v[0:1], v[102:103], v[100:101]
v_pk_fma_f32 v[104:105], v[16:17], v[106:107], v[104:105]
v_pk_fma_f32 v[102:103], v[102:103], v[48:49], v[102:103]
v_pk_fma_f32 v[106:107], v[106:107], v[56:57], v[106:107]
FL0_A0:
s_cmp_eq_u32 s49, 1
s_cbranch_scc1 FL0_F1
v_pk_fma_f32 v[100:101], v[100:101], v[50:51], v[100:101]
v_pk_fma_f32 v[104:105], v[104:105], v[58:59], v[104:105]
v_pk_fma_f32 v[100:101], v[2:3], v[102:103], v[100:101]
v_pk_fma_f32 v[104:105], v[18:19], v[106:107], v[104:105]
v_pk_fma_f32 v[102:103], v[102:103], v[50:51], v[102:103]
v_pk_fma_f32 v[106:107], v[106:107], v[58:59], v[106:107]
FL0_A1:
s_cmp_eq_u32 s49, 2
s_cbranch_scc1 FL0_F2
v_pk_fma_f32 v[100:101], v[100:101], v[52:53], v[100:101]
v_pk_fma_f32 v[104:105], v[104:105], v[60:61], v[104:105]
v_pk_fma_f32 v[100:101], v[4:5], v[102:103], v[100:101]
v_pk_fma_f32 v[104:105], v[20:21], v[106:107], v[104:105]
v_pk_fma_f32 v[102:103], v[102:103], v[52:53], v[102:103]
v_pk_fma_f32 v[106:107], v[106:107], v[60:61], v[106:107]
FL0_A2:
s_cmp_eq_u32 s49, 3
s_cbranch_scc1 FL0_F3
v_pk_fma_f32 v[100:101], v[100:101], v[54:55], v[100:101]
v_pk_fma_f32 v[104:105], v[104:105], v[62:63], v[104:105]
v_pk_fma_f32 v[100:101], v[6:7], v[102:103], v[100:101]
v_pk_fma_f32 v[104:105], v[22:23], v[106:107], v[104:105]
v_pk_fma_f32 v[102:103], v[102:103], v[54:55], v[102:103]
v_pk_fma_f32 v[106:107], v[106:107], v[62:63], v[106:107]
s_branch FL0_J0
FL0_C1:
s_cmp_eq_u32 s49, 4
s_cbranch_scc1 FL0_F4
v_pk_fma_f32 v[100:101], v[100:101], v[0:1], v[100:101]
v_pk_fma_f32 v[104:105], v[104:105], v[16:17], v[104:105]
v_pk_fma_f32 v[100:101], v[8:9], v[102:103], v[100:101]
v_pk_fma_f32 v[104:105], v[24:25], v[106:107], v[104:105]
v_pk_fma_f32 v[102:103], v[102:103], v[0:1], v[102:103]
v_pk_fma_f32 v[106:107], v[106:107], v[16:17], v[106:107]
FL0_A4:
s_cmp_eq_u32 s49, 5
s_cbranch_scc1 FL0_F5
v_pk_fma_f32 v[100:101], v[100:101], v[2:3], v[100:101]
v_pk_fma_f32 v[104:105], v[104:105], v[18:19], v[104:105]
v_pk_fma_f32 v[100:101], v[10:11], v[102:103], v[100:101]
v_pk_fma_f32 v[104:105], v[26:27], v[106:107], v[104:105]
v_pk_fma_f32 v[102:103], v[102:103], v[2:3], v[102:103]
v_pk_fma_f32 v[106:107], v[106:107], v[18:19], v[106:107]
FL0_A5:
s_cmp_eq_u32 s49, 6
s_cbranch_scc1 FL0_F6
v_pk_fma_f32 v[100:101], v[100:101], v[4:5], v[100:101]
v_pk_fma_f32 v[104:105], v[104:105], v[20:21], v[104:105]
v_pk_fma_f32 v[100:101], v[12:13], v[102:103], v[100:101]
v_pk_fma_f32 v[104:105], v[28:29], v[106:107], v[104:105]
v_pk_fma_f32 v[102:103], v[102:103], v[4:5], v[102:103]
v_pk_fma_f32 v[106:107], v[106:107], v[20:21], v[106:107]
FL0_A6:
s_cmp_eq_u32 s49, 7
s_cbranch_scc1 FL0_F7
v_pk_fma_f32 v[100:101], v[100:101], v[6:7], v[100:101]
v_pk_fma_f32 v[104:105], v[104:105], v[22:23], v[104:105]
v_pk_fma_f32 v[100:101], v[14:15], v[102:103], v[100:101]
v_pk_fma_f32 v[104:105], v[30:31], v[106:107], v[104:105]
v_pk_fma_f32 v[102:103], v[102:103], v[6:7], v[102:103]
v_pk_fma_f32 v[106:107], v[106:107], v[22:23], v[106:107]
s_branch FL0_J1
FL0_F0:
s_add_u32 s51, s51, 1
v_readlane_b32 s52, v127, s51
v_pk_mul_f32 v[110:111], v[100:101], v[102:103] op_sel:[0,1] op_sel_hi:[1,0]
v_mul_f32 v114, v102, v103
v_add_f32 v112, v110, v111
v_pk_mul_f32 v[110:111], v[104:105], v[106:107] op_sel:[0,1] op_sel_hi:[1,0]
v_mul_f32 v115, v106, v107
v_add_f32 v113, v110, v111
v_pk_fma_f32 v[108:109], v[114:115], 4.0, v[108:109] op_sel_hi:[1,0,1]
v_rcp_f32 v114, v114
v_rcp_f32 v115, v115
s_nop 0
v_pk_mul_f32 v[112:113], v[112:113], v[114:115]
v_cvt_f64_f32 v[110:111], v112
v_cvt_f64_f32 v[114:115], v113
ds_add_f64 v126, v[110:111]
ds_add_f64 v126, v[114:115] offset:256
v_pk_fma_f32 v[108:109], v[112:113], 0, v[108:109] op_sel_hi:[1,0,1]
v_add_u32 v126, 528, v126
s_sub_u32 s49, s52, s50
v_pk_add_f32 v[102:103], v[48:49], 1.0 op_sel_hi:[1,0]
v_pk_add_f32 v[100:101], v[0:1], 0 op_sel_hi:[1,0]
v_pk_add_f32 v[106:107], v[56:57], 1.0 op_sel_hi:[1,0]
v_pk_add_f32 v[104:105], v[16:17], 0 op_sel_hi:[1,0]
s_branch FL0_A0
FL0_F1:
s_add_u32 s51, s51, 1
v_readlane_b32 s52, v127, s51
v_pk_mul_f32 v[110:111], v[100:101], v[102:103] op_sel:[0,1] op_sel_hi:[1,0]
v_mul_f32 v114, v102, v103
v_add_f32 v112, v110, v111
v_pk_mul_f32 v[110:111], v[104:105], v[106:107] op_sel:[0,1] op_sel_hi:[1,0]
v_mul_f32 v115, v106, v107
v_add_f32 v113, v110, v111
v_pk_fma_f32 v[108:109], v[114:115], 4.0, v[108:109] op_sel_hi:[1,0,1]
v_rcp_f32 v114, v114
v_rcp_f32 v115, v115
s_nop 0
v_pk_mul_f32 v[112:113], v[112:113], v[114:115]
v_cvt_f64_f32 v[110:111], v112
v_cvt_f64_f32 v[114:115], v113
ds_add_f64 v126, v[110:111]
ds_add_f64 v126, v[114:115] offset:256
v_pk_fma_f32 v[108:109], v[112:113], 0, v[108:109] op_sel_hi:[1,0,1]
v_add_u32 v126, 528, v126
s_sub_u32 s49, s52, s50
v_pk_add_f32 v[102:103], v[50:51], 1.0 op_sel_hi:[1,0]
v_pk_add_f32 v[100:101], v[2:3], 0 op_sel_hi:[1,0]
v_pk_add_f32 v[106:107], v[58:59], 1.0 op_sel_hi:[1,0]
v_pk_add_f32 v[104:105], v[18:19], 0 op_sel_hi:[1,0]
s_branch FL0_A1
FL0_F2:
s_add_u32 s51, s51, 1
v_readlane_b32 s52, v127, s51
v_pk_mul_f32 v[110:111], v[100:101], v[102:103] op_sel:[0,1] op_sel_hi:[1,0]
v_mul_f32 v114, v102, v103
v_add_f32 v112, v110, v111
v_pk_mul_f32 v[110:111], v[104:105], v[106:107] op_sel:[0,1] op_sel_hi:[1,0]
v_mul_f32 v115, v106, v107
v_add_f32 v113, v110, v111
v_pk_fma_f32 v[108:109], v[114:115], 4.0, v[108:109] op_sel_hi:[1,0,1]
v_rcp_f32 v114, v114
v_rcp_f32 v115, v115
s_nop 0
v_pk_mul_f32 v[112:113], v[112:113], v[114:115]
v_cvt_f64_f32 v[110:111], v112
v_cvt_f64_f32 v[114:115], v113
ds_add_f64 v126, v[110:111]
ds_add_f64 v126, v[114:115] offset:256
v_pk_fma_f32 v[108:109], v[112:113], 0, v[108:109] op_sel_hi:[1,0,1]
v_add_u32 v126, 528, v126
s_sub_u32 s49, s52, s50
v_pk_add_f32 v[102:103], v[52:53], 1.0 op_sel_hi:[1,0]
v_pk_add_f32 v[100:101], v[4:5], 0 op_sel_hi:[1,0]
v_pk_add_f32 v[106:107], v[60:61], 1.0 op_sel_hi:[1,0]
v_pk_add_f32 v[104:105], v[20:21], 0 op_sel_hi:[1,0]
s_branch FL0_A2
FL0_F3:
s_add_u32 s51, s51, 1
v_readlane_b32 s52, v127, s51
v_pk_mul_f32 v[110:111], v[100:101], v[102:103] op_sel:[0,1] op_sel_hi:[1,0]
v_mul_f32 v114, v102, v103
v_add_f32 v112, v110, v111
v_pk_mul_f32 v[110:111], v[104:105], v[106:107] op_sel:[0,1] op_sel_hi:[1,0]
v_mul_f32 v115, v106, v107
v_add_f32 v113, v110, v111
v_pk_fma_f32 v[108:109], v[114:115], 4.0, v[108:109] op_sel_hi:[1,0,1]
v_rcp_f32 v114, v114
v_rcp_f32 v115, v115
s_nop 0
v_pk_mul_f32 v[112:113], v[112:113], v[114:115]
v_cvt_f64_f32 v[110:111], v112
v_cvt_f64_f32 v[114:115], v113
ds_add_f64 v126, v[110:111]
ds_add_f64 v126, v[114:115] offset:256
v_pk_fma_f32 v[108:109], v[112:113], 0, v[108:109] op_sel_hi:[1,0,1]
v_add_u32 v126, 528, v126
s_sub_u32 s49, s52, s50
v_pk_add_f32 v[102:103], v[54:55], 1.0 op_sel_hi:[1,0]
v_pk_add_f32 v[100:101], v[6:7], 0 op_sel_hi:[1,0]
v_pk_add_f32 v[106:107], v[62:63], 1.0 op_sel_hi:[1,0]
v_pk_add_f32 v[104:105], v[22:23], 0 op_sel_hi:[1,0]
s_branch FL0_J0
FL0_F4:
s_add_u32 s51, s51, 1
v_readlane_b32 s52, v127, s51
v_pk_mul_f32 v[110:111], v[100:101], v[102:103] op_sel:[0,1] op_sel_hi:[1,0]
v_mul_f32 v114, v102, v103
v_add_f32 v112, v110, v111
v_pk_mul_f32 v[110:111], v[104:105], v[106:107] op_sel:[0,1] op_sel_hi:[1,0]
v_mul_f32 v115, v106, v107
v_add_f32 v113, v110, v111
v_pk_fma_f32 v[108:109], v[114:115], 4.0, v[108:109] op_sel_hi:[1,0,1]
v_rcp_f32 v114, v114
v_rcp_f32 v115, v115
s_nop 0
v_pk_mul_f32 v[112:113], v[112:113], v[114:115]
v_cvt_f64_f32 v[110:111], v112
v_cvt_f64_f32 v[114:115], v113
ds_add_f64 v126, v[110:111]
ds_add_f64 v126, v[114:115] offset:256
v_pk_fma_f32 v[108:109], v[112:113], 0, v[108:109] op_sel_hi:[1,0,1]
v_add_u32 v126, 528, v126
s_sub_u32 s49, s52, s50
v_pk_add_f32 v[102:103], v[0:1], 1.0 op_sel_hi:[1,0]
v_pk_add_f32 v[100:101], v[8:9], 0 op_sel_hi:[1,0]
v_pk_add_f32 v[106:107], v[16:17], 1.0 op_sel_hi:[1,0]
v_pk_add_f32 v[104:105], v[24:25], 0 op_sel_hi:[1,0]
s_branch FL0_A4
FL0_F5:
s_add_u32 s51, s51, 1
v_readlane_b32 s52, v127, s51
v_pk_mul_f32 v[110:111], v[100:101], v[102:103] op_sel:[0,1] op_sel_hi:[1,0]
v_mul_f32 v114, v102, v103
v_add_f32 v112, v110, v111
v_pk_mul_f32 v[110:111], v[104:105], v[106:107] op_sel:[0,1] op_sel_hi:[1,0]
v_mul_f32 v115, v106, v107
v_add_f32 v113, v110, v111
v_pk_fma_f32 v[108:109], v[114:115], 4.0, v[108:109] op_sel_hi:[1,0,1]
v_rcp_f32 v114, v114
v_rcp_f32 v115, v115
s_nop 0
v_pk_mul_f32 v[112:113], v[112:113], v[114:115]
v_cvt_f64_f32 v[110:111], v112
v_cvt_f64_f32 v[114:115], v113
ds_add_f64 v126, v[110:111]
ds_add_f64 v126, v[114:115] offset:256
v_pk_fma_f32 v[108:109], v[112:113], 0, v[108:109] op_sel_hi:[1,0,1]
v_add_u32 v126, 528, v126
s_sub_u32 s49, s52, s50
v_pk_add_f32 v[102:103], v[2:3], 1.0 op_sel_hi:[1,0]
v_pk_add_f32 v[100:101], v[10:11], 0 op_sel_hi:[1,0]
v_pk_add_f32 v[106:107], v[18:19], 1.0 op_sel_hi:[1,0]
v_pk_add_f32 v[104:105], v[26:27], 0 op_sel_hi:[1,0]
s_branch FL0_A5
FL0_F6:
s_add_u32 s51, s51, 1
v_readlane_b32 s52, v127, s51
v_pk_mul_f32 v[110:111], v[100:101], v[102:103] op_sel:[0,1] op_sel_hi:[1,0]
v_mul_f32 v114, v102, v103
v_add_f32 v112, v110, v111
v_pk_mul_f32 v[110:111], v[104:105], v[106:107] op_sel:[0,1] op_sel_hi:[1,0]
v_mul_f32 v115, v106, v107
v_add_f32 v113, v110, v111
v_pk_fma_f32 v[108:109], v[114:115], 4.0, v[108:109] op_sel_hi:[1,0,1]
v_rcp_f32 v114, v114
v_rcp_f32 v115, v115
s_nop 0
v_pk_mul_f32 v[112:113], v[112:113], v[114:115]
v_cvt_f64_f32 v[110:111], v112
v_cvt_f64_f32 v[114:115], v113
ds_add_f64 v126, v[110:111]
ds_add_f64 v126, v[114:115] offset:256
v_pk_fma_f32 v[108:109], v[112:113], 0, v[108:109] op_sel_hi:[1,0,1]
v_add_u32 v126, 528, v126
s_sub_u32 s49, s52, s50
v_pk_add_f32 v[102:103], v[4:5], 1.0 op_sel_hi:[1,0]
v_pk_add_f32 v[100:101], v[12:13], 0 op_sel_hi:[1,0]
v_pk_add_f32 v[106:107], v[20:21], 1.0 op_sel_hi:[1,0]
v_pk_add_f32 v[104:105], v[28:29], 0 op_sel_hi:[1,0]
s_branch FL0_A6
FL0_F7:
s_add_u32 s51, s51, 1
v_readlane_b32 s52, v127, s51
v_pk_mul_f32 v[110:111], v[100:101], v[102:103] op_sel:[0,1] op_sel_hi:[1,0]
v_mul_f32 v114, v102, v103
v_add_f32 v112, v110, v111
v_pk_mul_f32 v[110:111], v[104:105], v[106:107] op_sel:[0,1] op_sel_hi:[1,0]
v_mul_f32 v115, v106, v107
v_add_f32 v113, v110, v111
v_pk_fma_f32 v[108:109], v[114:115], 4.0, v[108:109] op_sel_hi:[1,0,1]
v_rcp_f32 v114, v114
v_rcp_f32 v115, v115
s_nop 0
v_pk_mul_f32 v[112:113], v[112:113], v[114:115]
v_cvt_f64_f32 v[110:111], v112
v_cvt_f64_f32 v[114:115], v113
ds_add_f64 v126, v[110:111]
ds_add_f64 v126, v[114:115] offset:256
v_pk_fma_f32 v[108:109], v[112:113], 0, v[108:109] op_sel_hi:[1,0,1]
v_add_u32 v126, 528, v126
s_sub_u32 s49, s52, s50
v_pk_add_f32 v[102:103], v[6:7], 1.0 op_sel_hi:[1,0]
v_pk_add_f32 v[100:101], v[14:15], 0 op_sel_hi:[1,0]
v_pk_add_f32 v[106:107], v[22:23], 1.0 op_sel_hi:[1,0]
v_pk_add_f32 v[104:105], v[30:31], 0 op_sel_hi:[1,0]
s_branch FL0_J1
FL1_C0:
s_cmp_eq_u32 s49, 0
s_cbranch_scc1 FL1_F0
v_pk_fma_f32 v[100:101], v[100:101], v[16:17], v[100:101]
v_pk_fma_f32 v[104:105], v[104:105], v[24:25], v[104:105]
v_pk_fma_f32 v[100:101], v[32:33], v[102:103], v[100:101]
v_pk_fma_f32 v[104:105], v[48:49], v[106:107], v[104:105]
v_pk_fma_f32 v[102:103], v[102:103], v[16:17], v[102:103]
v_pk_fma_f32 v[106:107], v[106:107], v[24:25], v[106:107]
FL1_A0:
s_cmp_eq_u32 s49, 1
s_cbranch_scc1 FL1_F1
v_pk_fma_f32 v[100:101], v[100:101], v[18:19], v[100:101]
v_pk_fma_f32 v[104:105], v[104:105], v[26:27], v[104:105]
v_pk_fma_f32 v[100:101], v[34:35], v[102:103], v[100:101]
v_pk_fma_f32 v[104:105], v[50:51], v[106:107], v[104:105]
v_pk_fma_f32 v[102:103], v[102:103], v[18:19], v[102:103]
v_pk_fma_f32 v[106:107], v[106:107], v[26:27], v[106:107]
FL1_A1:
s_cmp_eq_u32 s49, 2
s_cbranch_scc1 FL1_F2
v_pk_fma_f32 v[100:101], v[100:101], v[20:21], v[100:101]
v_pk_fma_f32 v[104:105], v[104:105], v[28:29], v[104:105]
v_pk_fma_f32 v[100:101], v[36:37], v[102:103], v[100:101]
v_pk_fma_f32 v[104:105], v[52:53], v[106:107], v[104:105]
v_pk_fma_f32 v[102:103], v[102:103], v[20:21], v[102:103]
v_pk_fma_f32 v[106:107], v[106:107], v[28:29], v[106:107]
FL1_A2:
s_cmp_eq_u32 s49, 3
s_cbranch_scc1 FL1_F3
v_pk_fma_f32 v[100:101], v[100:101], v[22:23], v[100:101]
v_pk_fma_f32 v[104:105], v[104:105], v[30:31], v[104:105]
v_pk_fma_f32 v[100:101], v[38:39], v[102:103], v[100:101]
v_pk_fma_f32 v[104:105], v[54:55], v[106:107], v[104:105]
v_pk_fma_f32 v[102:103], v[102:103], v[22:23], v[102:103]
v_pk_fma_f32 v[106:107], v[106:107], v[30:31], v[106:107]
s_branch FL1_J0
FL1_C1:
s_cmp_eq_u32 s49, 4
s_cbranch_scc1 FL1_F4
v_pk_fma_f32 v[100:101], v[100:101], v[32:33], v[100:101]
v_pk_fma_f32 v[104:105], v[104:105], v[48:49], v[104:105]
v_pk_fma_f32 v[100:101], v[40:41], v[102:103], v[100:101]
v_pk_fma_f32 v[104:105], v[56:57], v[106:107], v[104:105]
v_pk_fma_f32 v[102:103], v[102:103], v[32:33], v[102:103]
v_pk_fma_f32 v[106:107], v[106:107], v[48:49], v[106:107]
FL1_A4:
s_cmp_eq_u32 s49, 5
s_cbranch_scc1 FL1_F5
v_pk_fma_f32 v[100:101], v[100:101], v[34:35], v[100:101]
v_pk_fma_f32 v[104:105], v[104:105], v[50:51], v[104:105]
v_pk_fma_f32 v[100:101], v[42:43], v[102:103], v[100:101]
v_pk_fma_f32 v[104:105], v[58:59], v[106:107], v[104:105]
v_pk_fma_f32 v[102:103], v[102:103], v[34:35], v[102:103]
v_pk_fma_f32 v[106:107], v[106:107], v[50:51], v[106:107]
FL1_A5:
s_cmp_eq_u32 s49, 6
s_cbranch_scc1 FL1_F6
v_pk_fma_f32 v[100:101], v[100:101], v[36:37], v[100:101]
v_pk_fma_f32 v[104:105], v[104:105], v[52:53], v[104:105]
v_pk_fma_f32 v[100:101], v[44:45], v[102:103], v[100:101]
v_pk_fma_f32 v[104:105], v[60:61], v[106:107], v[104:105]
v_pk_fma_f32 v[102:103], v[102:103], v[36:37], v[102:103]
v_pk_fma_f32 v[106:107], v[106:107], v[52:53], v[106:107]
FL1_A6:
s_cmp_eq_u32 s49, 7
s_cbranch_scc1 FL1_F7
v_pk_fma_f32 v[100:101], v[100:101], v[38:39], v[100:101]
v_pk_fma_f32 v[104:105], v[104:105], v[54:55], v[104:105]
v_pk_fma_f32 v[100:101], v[46:47], v[102:103], v[100:101]
v_pk_fma_f32 v[104:105], v[62:63], v[106:107], v[104:105]
v_pk_fma_f32 v[102:103], v[102:103], v[38:39], v[102:103]
v_pk_fma_f32 v[106:107], v[106:107], v[54:55], v[106:107]
s_branch FL1_J1
FL1_F0:
s_add_u32 s51, s51, 1
v_readlane_b32 s52, v127, s51
v_pk_mul_f32 v[110:111], v[100:101], v[102:103] op_sel:[0,1] op_sel_hi:[1,0]
v_mul_f32 v114, v102, v103
v_add_f32 v112, v110, v111
v_pk_mul_f32 v[110:111], v[104:105], v[106:107] op_sel:[0,1] op_sel_hi:[1,0]
v_mul_f32 v115, v106, v107
v_add_f32 v113, v110, v111
v_pk_fma_f32 v[108:109], v[114:115], 4.0, v[108:109] op_sel_hi:[1,0,1]
v_rcp_f32 v114, v114
v_rcp_f32 v115, v115
s_nop 0
v_pk_mul_f32 v[112:113], v[112:113], v[114:115]
v_cvt_f64_f32 v[110:111], v112
v_cvt_f64_f32 v[114:115], v113
ds_add_f64 v126, v[110:111]
ds_add_f64 v126, v[114:115] offset:256
v_pk_fma_f32 v[108:109], v[112:113], 0, v[108:109] op_sel_hi:[1,0,1]
v_add_u32 v126, 528, v126
s_sub_u32 s49, s52, s50
v_pk_add_f32 v[102:103], v[16:17], 1.0 op_sel_hi:[1,0]
v_pk_add_f32 v[100:101], v[32:33], 0 op_sel_hi:[1,0]
v_pk_add_f32 v[106:107], v[24:25], 1.0 op_sel_hi:[1,0]
v_pk_add_f32 v[104:105], v[48:49], 0 op_sel_hi:[1,0]
s_branch FL1_A0
FL1_F1:
s_add_u32 s51, s51, 1
v_readlane_b32 s52, v127, s51
v_pk_mul_f32 v[110:111], v[100:101], v[102:103] op_sel:[0,1] op_sel_hi:[1,0]
v_mul_f32 v114, v102, v103
v_add_f32 v112, v110, v111
v_pk_mul_f32 v[110:111], v[104:105], v[106:107] op_sel:[0,1] op_sel_hi:[1,0]
v_mul_f32 v115, v106, v107
v_add_f32 v113, v110, v111
v_pk_fma_f32 v[108:109], v[114:115], 4.0, v[108:109] op_sel_hi:[1,0,1]
v_rcp_f32 v114, v114
v_rcp_f32 v115, v115
s_nop 0
v_pk_mul_f32 v[112:113], v[112:113], v[114:115]
v_cvt_f64_f32 v[110:111], v112
v_cvt_f64_f32 v[114:115], v113
ds_add_f64 v126, v[110:111]
ds_add_f64 v126, v[114:115] offset:256
v_pk_fma_f32 v[108:109], v[112:113], 0, v[108:109] op_sel_hi:[1,0,1]
v_add_u32 v126, 528, v126
s_sub_u32 s49, s52, s50
v_pk_add_f32 v[102:103], v[18:19], 1.0 op_sel_hi:[1,0]
v_pk_add_f32 v[100:101], v[34:35], 0 op_sel_hi:[1,0]
v_pk_add_f32 v[106:107], v[26:27], 1.0 op_sel_hi:[1,0]
v_pk_add_f32 v[104:105], v[50:51], 0 op_sel_hi:[1,0]
s_branch FL1_A1
FL1_F2:
s_add_u32 s51, s51, 1
v_readlane_b32 s52, v127, s51
v_pk_mul_f32 v[110:111], v[100:101], v[102:103] op_sel:[0,1] op_sel_hi:[1,0]
v_mul_f32 v114, v102, v103
v_add_f32 v112, v110, v111
v_pk_mul_f32 v[110:111], v[104:105], v[106:107] op_sel:[0,1] op_sel_hi:[1,0]
v_mul_f32 v115, v106, v107
v_add_f32 v113, v110, v111
v_pk_fma_f32 v[108:109], v[114:115], 4.0, v[108:109] op_sel_hi:[1,0,1]
v_rcp_f32 v114, v114
v_rcp_f32 v115, v115
s_nop 0
v_pk_mul_f32 v[112:113], v[112:113], v[114:115]
v_cvt_f64_f32 v[110:111], v112
v_cvt_f64_f32 v[114:115], v113
ds_add_f64 v126, v[110:111]
ds_add_f64 v126, v[114:115] offset:256
v_pk_fma_f32 v[108:109], v[112:113], 0, v[108:109] op_sel_hi:[1,0,1]
v_add_u32 v126, 528, v126
s_sub_u32 s49, s52, s50
v_pk_add_f32 v[102:103], v[20:21], 1.0 op_sel_hi:[1,0]
v_pk_add_f32 v[100:101], v[36:37], 0 op_sel_hi:[1,0]
v_pk_add_f32 v[106:107], v[28:29], 1.0 op_sel_hi:[1,0]
v_pk_add_f32 v[104:105], v[52:53], 0 op_sel_hi:[1,0]
s_branch FL1_A2
FL1_F3:
s_add_u32 s51, s51, 1
v_readlane_b32 s52, v127, s51
v_pk_mul_f32 v[110:111], v[100:101], v[102:103] op_sel:[0,1] op_sel_hi:[1,0]
v_mul_f32 v114, v102, v103
v_add_f32 v112, v110, v111
v_pk_mul_f32 v[110:111], v[104:105], v[106:107] op_sel:[0,1] op_sel_hi:[1,0]
v_mul_f32 v115, v106, v107
v_add_f32 v113, v110, v111
v_pk_fma_f32 v[108:109], v[114:115], 4.0, v[108:109] op_sel_hi:[1,0,1]
v_rcp_f32 v114, v114
v_rcp_f32 v115, v115
s_nop 0
v_pk_mul_f32 v[112:113], v[112:113], v[114:115]
v_cvt_f64_f32 v[110:111], v112
v_cvt_f64_f32 v[114:115], v113
ds_add_f64 v126, v[110:111]
ds_add_f64 v126, v[114:115] offset:256
v_pk_fma_f32 v[108:109], v[112:113], 0, v[108:109] op_sel_hi:[1,0,1]
v_add_u32 v126, 528, v126
s_sub_u32 s49, s52, s50
v_pk_add_f32 v[102:103], v[22:23], 1.0 op_sel_hi:[1,0]
v_pk_add_f32 v[100:101], v[38:39], 0 op_sel_hi:[1,0]
v_pk_add_f32 v[106:107], v[30:31], 1.0 op_sel_hi:[1,0]
v_pk_add_f32 v[104:105], v[54:55], 0 op_sel_hi:[1,0]
s_branch FL1_J0
FL1_F4:
s_add_u32 s51, s51, 1
v_readlane_b32 s52, v127, s51
v_pk_mul_f32 v[110:111], v[100:101], v[102:103] op_sel:[0,1] op_sel_hi:[1,0]
v_mul_f32 v114, v102, v103
v_add_f32 v112, v110, v111
v_pk_mul_f32 v[110:111], v[104:105], v[106:107] op_sel:[0,1] op_sel_hi:[1,0]
v_mul_f32 v115, v106, v107
v_add_f32 v113, v110, v111
v_pk_fma_f32 v[108:109], v[114:115], 4.0, v[108:109] op_sel_hi:[1,0,1]
v_rcp_f32 v114, v114
v_rcp_f32 v115, v115
s_nop 0
v_pk_mul_f32 v[112:113], v[112:113], v[114:115]
v_cvt_f64_f32 v[110:111], v112
v_cvt_f64_f32 v[114:115], v113
ds_add_f64 v126, v[110:111]
ds_add_f64 v126, v[114:115] offset:256
v_pk_fma_f32 v[108:109], v[112:113], 0, v[108:109] op_sel_hi:[1,0,1]
v_add_u32 v126, 528, v126
s_sub_u32 s49, s52, s50
v_pk_add_f32 v[102:103], v[32:33], 1.0 op_sel_hi:[1,0]
v_pk_add_f32 v[100:101], v[40:41], 0 op_sel_hi:[1,0]
v_pk_add_f32 v[106:107], v[48:49], 1.0 op_sel_hi:[1,0]
v_pk_add_f32 v[104:105], v[56:57], 0 op_sel_hi:[1,0]
s_branch FL1_A4
FL1_F5:
s_add_u32 s51, s51, 1
v_readlane_b32 s52, v127, s51
v_pk_mul_f32 v[110:111], v[100:101], v[102:103] op_sel:[0,1] op_sel_hi:[1,0]
v_mul_f32 v114, v102, v103
v_add_f32 v112, v110, v111
v_pk_mul_f32 v[110:111], v[104:105], v[106:107] op_sel:[0,1] op_sel_hi:[1,0]
v_mul_f32 v115, v106, v107
v_add_f32 v113, v110, v111
v_pk_fma_f32 v[108:109], v[114:115], 4.0, v[108:109] op_sel_hi:[1,0,1]
v_rcp_f32 v114, v114
v_rcp_f32 v115, v115
s_nop 0
v_pk_mul_f32 v[112:113], v[112:113], v[114:115]
v_cvt_f64_f32 v[110:111], v112
v_cvt_f64_f32 v[114:115], v113
ds_add_f64 v126, v[110:111]
ds_add_f64 v126, v[114:115] offset:256
v_pk_fma_f32 v[108:109], v[112:113], 0, v[108:109] op_sel_hi:[1,0,1]
v_add_u32 v126, 528, v126
s_sub_u32 s49, s52, s50
v_pk_add_f32 v[102:103], v[34:35], 1.0 op_sel_hi:[1,0]
v_pk_add_f32 v[100:101], v[42:43], 0 op_sel_hi:[1,0]
v_pk_add_f32 v[106:107], v[50:51], 1.0 op_sel_hi:[1,0]
v_pk_add_f32 v[104:105], v[58:59], 0 op_sel_hi:[1,0]
s_branch FL1_A5
FL1_F6:
s_add_u32 s51, s51, 1
v_readlane_b32 s52, v127, s51
v_pk_mul_f32 v[110:111], v[100:101], v[102:103] op_sel:[0,1] op_sel_hi:[1,0]
v_mul_f32 v114, v102, v103
v_add_f32 v112, v110, v111
v_pk_mul_f32 v[110:111], v[104:105], v[106:107] op_sel:[0,1] op_sel_hi:[1,0]
v_mul_f32 v115, v106, v107
v_add_f32 v113, v110, v111
v_pk_fma_f32 v[108:109], v[114:115], 4.0, v[108:109] op_sel_hi:[1,0,1]
v_rcp_f32 v114, v114
v_rcp_f32 v115, v115
s_nop 0
v_pk_mul_f32 v[112:113], v[112:113], v[114:115]
v_cvt_f64_f32 v[110:111], v112
v_cvt_f64_f32 v[114:115], v113
ds_add_f64 v126, v[110:111]
ds_add_f64 v126, v[114:115] offset:256
v_pk_fma_f32 v[108:109], v[112:113], 0, v[108:109] op_sel_hi:[1,0,1]
v_add_u32 v126, 528, v126
s_sub_u32 s49, s52, s50
v_pk_add_f32 v[102:103], v[36:37], 1.0 op_sel_hi:[1,0]
v_pk_add_f32 v[100:101], v[44:45], 0 op_sel_hi:[1,0]
v_pk_add_f32 v[106:107], v[52:53], 1.0 op_sel_hi:[1,0]
v_pk_add_f32 v[104:105], v[60:61], 0 op_sel_hi:[1,0]
s_branch FL1_A6
FL1_F7:
s_add_u32 s51, s51, 1
v_readlane_b32 s52, v127, s51
v_pk_mul_f32 v[110:111], v[100:101], v[102:103] op_sel:[0,1] op_sel_hi:[1,0]
v_mul_f32 v114, v102, v103
v_add_f32 v112, v110, v111
v_pk_mul_f32 v[110:111], v[104:105], v[106:107] op_sel:[0,1] op_sel_hi:[1,0]
v_mul_f32 v115, v106, v107
v_add_f32 v113, v110, v111
v_pk_fma_f32 v[108:109], v[114:115], 4.0, v[108:109] op_sel_hi:[1,0,1]
v_rcp_f32 v114, v114
v_rcp_f32 v115, v115
s_nop 0
v_pk_mul_f32 v[112:113], v[112:113], v[114:115]
v_cvt_f64_f32 v[110:111], v112
v_cvt_f64_f32 v[114:115], v113
ds_add_f64 v126, v[110:111]
ds_add_f64 v126, v[114:115] offset:256
v_pk_fma_f32 v[108:109], v[112:113], 0, v[108:109] op_sel_hi:[1,0,1]
v_add_u32 v126, 528, v126
s_sub_u32 s49, s52, s50
v_pk_add_f32 v[102:103], v[38:39], 1.0 op_sel_hi:[1,0]
v_pk_add_f32 v[100:101], v[46:47], 0 op_sel_hi:[1,0]
v_pk_add_f32 v[106:107], v[54:55], 1.0 op_sel_hi:[1,0]
v_pk_add_f32 v[104:105], v[62:63], 0 op_sel_hi:[1,0]
s_branch FL1_J1
K2_pre2:
s_nop 15
s_cmp_eq_u32 s29, 0
s_cbranch_scc1 FL0
s_branch SL0
K2_notiles:
s_waitcnt vmcnt(0)
s_mov_b32 m0, 0
s_lshl_b32 s52, s65, 7
ds_read_addtid_b32 v124 offset:41600
ds_read_addtid_b32 v88 offset:41856
ds_read_addtid_b32 v120 offset:42112
ds_read_addtid_b32 v121 offset:42368
ds_read_addtid_b32 v122 offset:42624
ds_read_addtid_b32 v123 offset:42880
ds_read_addtid_b32 v125 offset:43136
ds_read_addtid_b32 v90 offset:43392
ds_read_addtid_b32 v91 offset:43648
s_waitcnt lgkmcnt(7)
v_add_u32 v88, s52, v88
s_mov_b32 m0, s56
s_add_u32 s52, s61, 0
buffer_load_dwordx4 v124, s[72:75], s52 offen lds
s_mov_b32 m0, s57
s_add_u32 s52, s61, 4096
buffer_load_dwordx4 v124, s[72:75], s52 offen lds
s_mov_b32 m0, s58
s_add_u32 s52, s61, 8192
buffer_load_dwordx4 v124, s[72:75], s52 offen lds
s_mov_b32 m0, s59
s_add_u32 s52, s61, 12288
buffer_load_dwordx4 v124, s[72:75], s52 offen lds
v_xor_b32 v89, 64, v88
ds_read_b128 v[64:67], v88 offset:61312
ds_read_b128 v[68:71], v89 offset:61312
s_mul_i32 s52, s28, 2112
s_add_u32 s52, s52, 69504
s_mul_i32 s53, s28, 576
s_add_u32 s53, s53, 96000
s_waitcnt lgkmcnt(2)
v_add_u32 v120, s52, v120
v_add_u32 v121, s53, v121
s_mul_i32 s52, s65, 144
s_add_u32 s52, s52, 96000
s_add_u32 s53, s52, s61
v_add_u32 v122, s52, v122
v_add_u32 v123, s53, v123
s_mul_i32 s52, s28, 1152
s_add_u32 s52, s52, 96000
s_lshl_b32 s53, s28, 11
s_add_u32 s53, s53, s64
s_lshl_b32 s53, s53, 7
v_add_u32 v90, s52, v90
v_add_u32 v91, s53, v91
v_add_u32 v125, s56, v125
s_waitcnt vmcnt(0)
ds_read_b64_tr_b16 v[72:73], v125 offset:0
ds_read_b64_tr_b16 v[74:75], v125 offset:128
ds_read_b64_tr_b16 v[76:77], v125 offset:1024
ds_read_b64_tr_b16 v[78:79], v125 offset:1152
ds_read_b64_tr_b16 v[80:81], v125 offset:2048
ds_read_b64_tr_b16 v[82:83], v125 offset:2176
ds_read_b64_tr_b16 v[84:85], v125 offset:3072
ds_read_b64_tr_b16 v[86:87], v125 offset:3200
s_waitcnt lgkmcnt(0)
v_mfma_f32_16x16x32_bf16 v[116:119], v[72:75], v[64:67], 0
v_mfma_f32_16x16x32_bf16 v[116:119], v[76:79], v[68:71], v[116:119]
K2_join:
v_add_f32 v108, v108, v109
v_mov_b32 v0, 0x207
v_cmp_class_f32 vcc, v108, v0
s_cbranch_vccz K2_ok
v_mov_b32 v0, 38928
v_mov_b32 v1, 1
ds_write_b32 v0, v1
K2_ok:
v_mov_b32 v6, 38912
s_mov_b32 s66, 0xbf317218
s_mov_b32 s67, 0xbf317218
s_waitcnt lgkmcnt(0)
s_barrier
ds_read_b128 v[12:15], v120
ds_read_b128 v[16:19], v120 offset:16
ds_read2_b32 v[8:9], v6 offset0:0 offset1:4
s_waitcnt lgkmcnt(2)
v_cvt_f32_f64 v20, v[12:13]
v_cvt_f32_f64 v21, v[14:15]
s_waitcnt lgkmcnt(1)
v_cvt_f32_f64 v22, v[16:17]
v_cvt_f32_f64 v23, v[18:19]
v_pk_mul_f32 v[20:21], v[20:21], s[66:67]
v_pk_mul_f32 v[22:23], v[22:23], s[66:67]
v_cvt_pk_bf16_f32 v20, v20, v21
v_cvt_pk_bf16_f32 v21, v22, v23
ds_write_b64 v121, v[20:21]
s_waitcnt lgkmcnt(1)
v_readfirstlane_b32 s52, v8
v_readfirstlane_b32 s53, v9
s_andn2_b32 s53, s53, s29
s_or_b32 s54, s52, s53
s_cbranch_scc1 K2_rare
s_mov_b32 s66, 0xbfb8aa3b
s_mov_b32 s67, 0xbfb8aa3b
s_waitcnt lgkmcnt(0)
s_barrier
ds_read_b128 v[36:39], v122
ds_read_b128 v[40:43], v122 offset:64
s_waitcnt lgkmcnt(1)
v_mfma_f32_16x16x32_bf16 v[32:35], v[80:83], v[36:39], v[116:119]
s_waitcnt lgkmcnt(0)
v_mfma_f32_16x16x32_bf16 v[32:35], v[84:87], v[40:43], v[32:35]
s_nop 7
v_cvt_pk_bf16_f32 v12, v32, v33
v_cvt_pk_bf16_f32 v13, v34, v35
v_lshlrev_b32 v16, 16, v12
v_and_b32 v17, 0xffff0000, v12
v_lshlrev_b32 v18, 16, v13
v_and_b32 v19, 0xffff0000, v13
v_pk_mul_f32 v[20:21], v[16:17], s[66:67]
v_pk_mul_f32 v[22:23], v[18:19], s[66:67]
v_exp_f32 v20, v20
v_exp_f32 v21, v21
v_exp_f32 v22, v22
v_exp_f32 v23, v23
v_pk_add_f32 v[20:21], v[20:21], 1.0 op_sel_hi:[1,0]
v_pk_add_f32 v[22:23], v[22:23], 1.0 op_sel_hi:[1,0]
v_rcp_f32 v20, v20
v_rcp_f32 v21, v21
v_rcp_f32 v22, v22
v_rcp_f32 v23, v23
v_pk_mul_f32 v[20:21], v[16:17], v[20:21]
v_pk_mul_f32 v[22:23], v[18:19], v[22:23]
v_cvt_pk_bf16_f32 v12, v20, v21
v_cvt_pk_bf16_f32 v13, v22, v23
ds_write_b64 v123, v[12:13] offset:16384
s_cmp_lt_u32 s28, 7
s_waitcnt lgkmcnt(0)
s_barrier
s_cbranch_scc0 K2_done
ds_read_b128 v[12:15], v90 offset:16384
s_waitcnt lgkmcnt(0)
buffer_store_dwordx4 v[12:15], v91, s[20:23], 0 offen
K2_done:
s_endpgm
K2_big:
s_mov_b32 s31, 12
s_mov_b32 s52, 0
s_mov_b32 s53, 0
s_branch K2_again
K2_rare:
s_mov_b32 s52, s31
K2_again:
s_waitcnt vmcnt(0) lgkmcnt(0)
s_barrier
s_sub_u32 s2, s2, 1
s_cmp_eq_u32 s2, 0
s_cbranch_scc1 K2_done
v_mbcnt_lo_u32_b32 v1, -1, 0
v_mbcnt_hi_u32_b32 v1, -1, v1
s_lshl_b32 s55, s28, 6
v_add_u32 v0, s55, v1
s_add_u32 s30, s30, s52
s_mul_i32 s52, s52, 0x5556
s_lshr_b32 s52, s52, 12
s_and_b32 s52, s52, -16
s_add_u32 s69, s69, s52
s_mov_b32 s48, 0
s_cmp_lg_u32 s53, 0
s_cbranch_scc0 K2_round
s_mov_b32 s29, 1
s_branch K2_restart
SD0:
v_exp_f32 v48, v0
v_exp_f32 v49, v1
v_exp_f32 v56, v16
v_exp_f32 v57, v17
v_exp_f32 v50, v2
v_exp_f32 v51, v3
v_exp_f32 v58, v18
v_exp_f32 v59, v19
v_exp_f32 v52, v4
v_exp_f32 v53, v5
v_exp_f32 v60, v20
v_exp_f32 v61, v21
v_exp_f32 v54, v6
v_exp_f32 v55, v7
v_exp_f32 v62, v22
v_exp_f32 v63, v23
s_cmp_lt_u32 s49, 4
s_cbranch_scc1 SD0_C0
v_pk_add_f32 v[48:49], v[48:49], 1.0 op_sel_hi:[1,0]
v_pk_add_f32 v[56:57], v[56:57], 1.0 op_sel_hi:[1,0]
v_rcp_f32 v48, v48
v_rcp_f32 v49, v49
v_rcp_f32 v56, v56
v_rcp_f32 v57, v57
s_nop 0
v_pk_fma_f32 v[100:101], v[0:1], v[48:49], v[100:101]
v_pk_fma_f32 v[104:105], v[16:17], v[56:57], v[104:105]
v_pk_add_f32 v[50:51], v[50:51], 1.0 op_sel_hi:[1,0]
v_pk_add_f32 v[58:59], v[58:59], 1.0 op_sel_hi:[1,0]
v_rcp_f32 v50, v50
v_rcp_f32 v51, v51
v_rcp_f32 v58, v58
v_rcp_f32 v59, v59
s_nop 0
v_pk_fma_f32 v[100:101], v[2:3], v[50:51], v[100:101]
v_pk_fma_f32 v[104:105], v[18:19], v[58:59], v[104:105]
v_pk_add_f32 v[52:53], v[52:53], 1.0 op_sel_hi:[1,0]
v_pk_add_f32 v[60:61], v[60:61], 1.0 op_sel_hi:[1,0]
v_rcp_f32 v52, v52
v_rcp_f32 v53, v53
v_rcp_f32 v60, v60
v_rcp_f32 v61, v61
s_nop 0
v_pk_fma_f32 v[100:101], v[4:5], v[52:53], v[100:101]
v_pk_fma_f32 v[104:105], v[20:21], v[60:61], v[104:105]
v_pk_add_f32 v[54:55], v[54:55], 1.0 op_sel_hi:[1,0]
v_pk_add_f32 v[62:63], v[62:63], 1.0 op_sel_hi:[1,0]
v_rcp_f32 v54, v54
v_rcp_f32 v55, v55
v_rcp_f32 v62, v62
v_rcp_f32 v63, v63
s_nop 0
v_pk_fma_f32 v[100:101], v[6:7], v[54:55], v[100:101]
v_pk_fma_f32 v[104:105], v[22:23], v[62:63], v[104:105]
SD0_J0:
v_exp_f32 v0, v8
v_exp_f32 v1, v9
v_exp_f32 v16, v24
v_exp_f32 v17, v25
v_exp_f32 v2, v10
v_exp_f32 v3, v11
v_exp_f32 v18, v26
v_exp_f32 v19, v27
v_exp_f32 v4, v12
v_exp_f32 v5, v13
v_exp_f32 v20, v28
v_exp_f32 v21, v29
v_exp_f32 v6, v14
v_exp_f32 v7, v15
v_exp_f32 v22, v30
v_exp_f32 v23, v31
s_cmp_lt_u32 s49, 8
s_cbranch_scc1 SD0_C1
v_pk_add_f32 v[0:1], v[0:1], 1.0 op_sel_hi:[1,0]
v_pk_add_f32 v[16:17], v[16:17], 1.0 op_sel_hi:[1,0]
v_rcp_f32 v0, v0
v_rcp_f32 v1, v1
v_rcp_f32 v16, v16
v_rcp_f32 v17, v17
s_nop 0
v_pk_fma_f32 v[100:101], v[8:9], v[0:1], v[100:101]
v_pk_fma_f32 v[104:105], v[24:25], v[16:17], v[104:105]
v_pk_add_f32 v[2:3], v[2:3], 1.0 op_sel_hi:[1,0]
v_pk_add_f32 v[18:19], v[18:19], 1.0 op_sel_hi:[1,0]
v_rcp_f32 v2, v2
v_rcp_f32 v3, v3
v_rcp_f32 v18, v18
v_rcp_f32 v19, v19
s_nop 0
v_pk_fma_f32 v[100:101], v[10:11], v[2:3], v[100:101]
v_pk_fma_f32 v[104:105], v[26:27], v[18:19], v[104:105]
v_pk_add_f32 v[4:5], v[4:5], 1.0 op_sel_hi:[1,0]
v_pk_add_f32 v[20:21], v[20:21], 1.0 op_sel_hi:[1,0]
v_rcp_f32 v4, v4
v_rcp_f32 v5, v5
v_rcp_f32 v20, v20
v_rcp_f32 v21, v21
s_nop 0
v_pk_fma_f32 v[100:101], v[12:13], v[4:5], v[100:101]
v_pk_fma_f32 v[104:105], v[28:29], v[20:21], v[104:105]
v_pk_add_f32 v[6:7], v[6:7], 1.0 op_sel_hi:[1,0]
v_pk_add_f32 v[22:23], v[22:23], 1.0 op_sel_hi:[1,0]
v_rcp_f32 v6, v6
v_rcp_f32 v7, v7
v_rcp_f32 v22, v22
v_rcp_f32 v23, v23
s_nop 0
v_pk_fma_f32 v[100:101], v[14:15], v[6:7], v[100:101]
v_pk_fma_f32 v[104:105], v[30:31], v[22:23], v[104:105]
SD0_J1:
s_waitcnt vmcnt(0)
ds_read_b128 v[64:67], v120 offset:0
ds_read_b128 v[68:71], v121 offset:0
ds_read_b128 v[72:75], v120 offset:2048
ds_read_b128 v[76:79], v121 offset:2048
ds_read_u16 v116, v123 offset:512
ds_read_u16 v118, v123 offset:640
ds_read_b64 v[80:81], v122 offset:512
s_add_u32 s50, s50, 8
s_sub_u32 s49, s49, 8
s_sub_u32 s48, s48, 1
s_waitcnt lgkmcnt(1)
v_mfma_f32_32x32x16_bf16 v[32:47], v[64:67], v[92:95], 0
v_mfma_f32_32x32x16_bf16 v[32:47], v[68:71], v[96:99], v[32:47]
v_mfma_f32_32x32x8_bf16 v[32:47], v[82:83], v[84:85], v[32:47]
v_mfma_f32_32x32x16_bf16 v[48:63], v[72:75], v[92:95], 0
v_mfma_f32_32x32x16_bf16 v[48:63], v[76:79], v[96:99], v[48:63]
v_mfma_f32_32x32x8_bf16 v[48:63], v[82:83], v[86:87], v[48:63]
s_cmp_eq_u32 s48, 0
s_cbranch_scc1 SL1n
s_mov_b32 m0, s56
s_nop 0
buffer_load_dwordx4 v[116:117], s[16:19], 0 idxen offen lds
s_mov_b32 m0, s57
s_nop 0
buffer_load_dwordx4 v[118:119], s[16:19], 0 idxen offen lds
s_mov_b32 m0, s58
s_nop 0
buffer_load_dwordx4 v[116:117], s[16:19], s60 idxen offen lds
s_mov_b32 m0, s59
s_nop 0
buffer_load_dwordx4 v[118:119], s[16:19], s60 idxen offen lds
s_add_u32 s54, s50, 8
v_cmp_ge_u32 vcc, s54, v127
s_bcnt1_i32_b64 s52, vcc
s_mul_i32 s53, s52, -4
s_mul_i32 s52, s52, 272
v_add_u32 v111, s52, v125
s_waitcnt lgkmcnt(0)
v_add3_u32 v110, v81, v124, s53
ds_read_b32 v85, v111 offset:0
ds_read_b32 v87, v111 offset:128
ds_read_b32 v81, v110
SE1:
v_exp_f32 v16, v32
v_exp_f32 v17, v33
v_exp_f32 v24, v48
v_exp_f32 v25, v49
v_exp_f32 v18, v34
v_exp_f32 v19, v35
v_exp_f32 v26, v50
v_exp_f32 v27, v51
v_exp_f32 v20, v36
v_exp_f32 v21, v37
v_exp_f32 v28, v52
v_exp_f32 v29, v53
v_exp_f32 v22, v38
v_exp_f32 v23, v39
v_exp_f32 v30, v54
v_exp_f32 v31, v55
s_waitcnt vmcnt(0)
ds_read_b128 v[64:67], v120 offset:0
ds_read_b128 v[68:71], v121 offset:0
ds_read_b128 v[72:75], v120 offset:2048
ds_read_b128 v[76:79], v121 offset:2048
ds_read_u16 v116, v123 offset:768
ds_read_u16 v118, v123 offset:896
s_cmp_lt_u32 s49, 4
s_cbranch_scc1 SE1_C0
v_pk_add_f32 v[16:17], v[16:17], 1.0 op_sel_hi:[1,0]
v_pk_add_f32 v[24:25], v[24:25], 1.0 op_sel_hi:[1,0]
v_rcp_f32 v16, v16
v_rcp_f32 v17, v17
v_rcp_f32 v24, v24
v_rcp_f32 v25, v25
s_nop 0
v_pk_fma_f32 v[100:101], v[32:33], v[16:17], v[100:101]
v_pk_fma_f32 v[104:105], v[48:49], v[24:25], v[104:105]
v_pk_add_f32 v[18:19], v[18:19], 1.0 op_sel_hi:[1,0]
v_pk_add_f32 v[26:27], v[26:27], 1.0 op_sel_hi:[1,0]
v_rcp_f32 v18, v18
v_rcp_f32 v19, v19
v_rcp_f32 v26, v26
v_rcp_f32 v27, v27
s_nop 0
v_pk_fma_f32 v[100:101], v[34:35], v[18:19], v[100:101]
v_pk_fma_f32 v[104:105], v[50:51], v[26:27], v[104:105]
v_pk_add_f32 v[20:21], v[20:21], 1.0 op_sel_hi:[1,0]
v_pk_add_f32 v[28:29], v[28:29], 1.0 op_sel_hi:[1,0]
v_rcp_f32 v20, v20
v_rcp_f32 v21, v21
v_rcp_f32 v28, v28
v_rcp_f32 v29, v29
s_nop 0
v_pk_fma_f32 v[100:101], v[36:37], v[20:21], v[100:101]
v_pk_fma_f32 v[104:105], v[52:53], v[28:29], v[104:105]
v_pk_add_f32 v[22:23], v[22:23], 1.0 op_sel_hi:[1,0]
v_pk_add_f32 v[30:31], v[30:31], 1.0 op_sel_hi:[1,0]
v_rcp_f32 v22, v22
v_rcp_f32 v23, v23
v_rcp_f32 v30, v30
v_rcp_f32 v31, v31
s_nop 0
v_pk_fma_f32 v[100:101], v[38:39], v[22:23], v[100:101]
v_pk_fma_f32 v[104:105], v[54:55], v[30:31], v[104:105]
SE1_J0:
s_waitcnt lgkmcnt(0)
s_cmp_lt_u32 s48, 2
s_cbranch_scc1 SE1_ng
s_mov_b32 m0, s56
s_nop 0
buffer_load_dwordx4 v[116:117], s[16:19], 0 idxen offen lds
s_mov_b32 m0, s57
s_nop 0
buffer_load_dwordx4 v[118:119], s[16:19], 0 idxen offen lds
s_mov_b32 m0, s58
s_nop 0
buffer_load_dwordx4 v[116:117], s[16:19], s60 idxen offen lds
s_mov_b32 m0, s59
s_nop 0
buffer_load_dwordx4 v[118:119], s[16:19], s60 idxen offen lds
SE1_ng:
ds_read_b64 v[82:83], v122 offset:768
v_mfma_f32_32x32x16_bf16 v[0:15], v[64:67], v[92:95], 0
v_exp_f32 v32, v40
v_exp_f32 v33, v41
v_exp_f32 v48, v56
v_mfma_f32_32x32x16_bf16 v[0:15], v[68:71], v[96:99], v[0:15]
v_exp_f32 v49, v57
v_exp_f32 v34, v42
v_exp_f32 v35, v43
v_mfma_f32_32x32x8_bf16 v[0:15], v[80:81], v[84:85], v[0:15]
v_exp_f32 v50, v58
v_exp_f32 v51, v59
v_exp_f32 v36, v44
v_mfma_f32_32x32x16_bf16 v[16:31], v[72:75], v[92:95], 0
v_exp_f32 v37, v45
v_exp_f32 v52, v60
v_exp_f32 v53, v61
v_mfma_f32_32x32x16_bf16 v[16:31], v[76:79], v[96:99], v[16:31]
v_exp_f32 v38, v46
v_exp_f32 v39, v47
v_exp_f32 v54, v62
v_mfma_f32_32x32x8_bf16 v[16:31], v[80:81], v[86:87], v[16:31]
v_exp_f32 v55, v63
s_waitcnt lgkmcnt(0)
s_cmp_lt_u32 s48, 2
s_cbranch_scc1 SE1_nr
s_add_u32 s54, s50, 16
v_cmp_ge_u32 vcc, s54, v127
s_bcnt1_i32_b64 s52, vcc
s_mul_i32 s53, s52, -4
s_mul_i32 s52, s52, 272
v_add_u32 v111, s52, v125
v_add3_u32 v110, v83, v124, s53
ds_read_b32 v85, v111 offset:0
ds_read_b32 v87, v111 offset:128
ds_read_b32 v83, v110
SE1_nr:
s_cmp_lt_u32 s49, 8
s_cbranch_scc1 SE1_C1
v_pk_add_f32 v[32:33], v[32:33], 1.0 op_sel_hi:[1,0]
v_pk_add_f32 v[48:49], v[48:49], 1.0 op_sel_hi:[1,0]
v_rcp_f32 v32, v32
v_rcp_f32 v33, v33
v_rcp_f32 v48, v48
v_rcp_f32 v49, v49
s_nop 0
v_pk_fma_f32 v[100:101], v[40:41], v[32:33], v[100:101]
v_pk_fma_f32 v[104:105], v[56:57], v[48:49], v[104:105]
v_pk_add_f32 v[34:35], v[34:35], 1.0 op_sel_hi:[1,0]
v_pk_add_f32 v[50:51], v[50:51], 1.0 op_sel_hi:[1,0]
v_rcp_f32 v34, v34
v_rcp_f32 v35, v35
v_rcp_f32 v50, v50
v_rcp_f32 v51, v51
s_nop 0
v_pk_fma_f32 v[100:101], v[42:43], v[34:35], v[100:101]
v_pk_fma_f32 v[104:105], v[58:59], v[50:51], v[104:105]
v_pk_add_f32 v[36:37], v[36:37], 1.0 op_sel_hi:[1,0]
v_pk_add_f32 v[52:53], v[52:53], 1.0 op_sel_hi:[1,0]
v_rcp_f32 v36, v36
v_rcp_f32 v37, v37
v_rcp_f32 v52, v52
v_rcp_f32 v53, v53
s_nop 0
v_pk_fma_f32 v[100:101], v[44:45], v[36:37], v[100:101]
v_pk_fma_f32 v[104:105], v[60:61], v[52:53], v[104:105]
v_pk_add_f32 v[38:39], v[38:39], 1.0 op_sel_hi:[1,0]
v_pk_add_f32 v[54:55], v[54:55], 1.0 op_sel_hi:[1,0]
v_rcp_f32 v38, v38
v_rcp_f32 v39, v39
v_rcp_f32 v54, v54
v_rcp_f32 v55, v55
s_nop 0
v_pk_fma_f32 v[100:101], v[46:47], v[38:39], v[100:101]
v_pk_fma_f32 v[104:105], v[62:63], v[54:55], v[104:105]
SE1_J1:
s_cmp_lt_u32 s48, 2
s_cbranch_scc1 SE1_nl
s_waitcnt vmcnt(0)
ds_read_b128 v[64:67], v120 offset:0
ds_read_b128 v[68:71], v121 offset:0
ds_read_b128 v[72:75], v120 offset:2048
ds_read_b128 v[76:79], v121 offset:2048
ds_read_u16 v116, v123 offset:1024
ds_read_u16 v118, v123 offset:1152
SE1_nl:
v_add_u32 v122, 512, v122
v_add_u32 v123, 512, v123
s_add_u32 s50, s50, 8
s_sub_u32 s49, s49, 8
s_sub_u32 s48, s48, 1
s_cmp_eq_u32 s48, 0
s_cbranch_scc1 SL0
SM0:
s_cmp_lt_u32 s48, 3
s_cbranch_scc1 SM0_lo
SM0_g:
s_waitcnt lgkmcnt(0)
s_mov_b32 m0, s56
s_nop 0
buffer_load_dwordx4 v[116:117], s[16:19], 0 idxen offen lds
s_mov_b32 m0, s57
s_nop 0
buffer_load_dwordx4 v[118:119], s[16:19], 0 idxen offen lds
s_mov_b32 m0, s58
s_nop 0
buffer_load_dwordx4 v[116:117], s[16:19], s60 idxen offen lds
s_mov_b32 m0, s59
s_nop 0
buffer_load_dwordx4 v[118:119], s[16:19], s60 idxen offen lds
SM0_ng:
v_mfma_f32_32x32x16_bf16 v[32:47], v[64:67], v[92:95], 0
v_exp_f32 v48, v0
v_exp_f32 v49, v1
v_exp_f32 v56, v16
v_exp_f32 v57, v17
v_mfma_f32_32x32x16_bf16 v[32:47], v[68:71], v[96:99], v[32:47]
v_exp_f32 v50, v2
v_exp_f32 v51, v3
v_exp_f32 v58, v18
v_exp_f32 v59, v19
v_mfma_f32_32x32x8_bf16 v[32:47], v[82:83], v[84:85], v[32:47]
v_exp_f32 v52, v4
v_exp_f32 v53, v5
v_exp_f32 v60, v20
v_exp_f32 v61, v21
v_exp_f32 v54, v6
v_exp_f32 v55, v7
v_exp_f32 v62, v22
v_exp_f32 v63, v23
s_cmp_lt_u32 s49, 4
s_cbranch_scc1 SM0_C0
v_pk_add_f32 v[48:49], v[48:49], 1.0 op_sel_hi:[1,0]
v_pk_add_f32 v[56:57], v[56:57], 1.0 op_sel_hi:[1,0]
v_rcp_f32 v48, v48
v_rcp_f32 v49, v49
v_rcp_f32 v56, v56
v_rcp_f32 v57, v57
s_nop 0
v_pk_fma_f32 v[100:101], v[0:1], v[48:49], v[100:101]
v_pk_fma_f32 v[104:105], v[16:17], v[56:57], v[104:105]
v_pk_add_f32 v[50:51], v[50:51], 1.0 op_sel_hi:[1,0]
v_pk_add_f32 v[58:59], v[58:59], 1.0 op_sel_hi:[1,0]
v_rcp_f32 v50, v50
v_rcp_f32 v51, v51
v_rcp_f32 v58, v58
v_rcp_f32 v59, v59
s_nop 0
v_pk_fma_f32 v[100:101], v[2:3], v[50:51], v[100:101]
v_pk_fma_f32 v[104:105], v[18:19], v[58:59], v[104:105]
v_pk_add_f32 v[52:53], v[52:53], 1.0 op_sel_hi:[1,0]
v_pk_add_f32 v[60:61], v[60:61], 1.0 op_sel_hi:[1,0]
v_rcp_f32 v52, v52
v_rcp_f32 v53, v53
v_rcp_f32 v60, v60
v_rcp_f32 v61, v61
s_nop 0
v_pk_fma_f32 v[100:101], v[4:5], v[52:53], v[100:101]
v_pk_fma_f32 v[104:105], v[20:21], v[60:61], v[104:105]
v_pk_add_f32 v[54:55], v[54:55], 1.0 op_sel_hi:[1,0]
v_pk_add_f32 v[62:63], v[62:63], 1.0 op_sel_hi:[1,0]
v_rcp_f32 v54, v54
v_rcp_f32 v55, v55
v_rcp_f32 v62, v62
v_rcp_f32 v63, v63
s_nop 0
v_pk_fma_f32 v[100:101], v[6:7], v[54:55], v[100:101]
v_pk_fma_f32 v[104:105], v[22:23], v[62:63], v[104:105]
SM0_J0:
ds_read_b64 v[80:81], v122 offset:512
v_mfma_f32_32x32x16_bf16 v[48:63], v[72:75], v[92:95], 0
v_exp_f32 v0, v8
v_exp_f32 v1, v9
v_exp_f32 v16, v24
v_exp_f32 v17, v25
v_mfma_f32_32x32x16_bf16 v[48:63], v[76:79], v[96:99], v[48:63]
v_exp_f32 v2, v10
v_exp_f32 v3, v11
v_exp_f32 v18, v26
v_exp_f32 v19, v27
v_mfma_f32_32x32x8_bf16 v[48:63], v[82:83], v[86:87], v[48:63]
v_exp_f32 v4, v12
v_exp_f32 v5, v13
v_exp_f32 v20, v28
v_exp_f32 v21, v29
v_exp_f32 v6, v14
v_exp_f32 v7, v15
v_exp_f32 v22, v30
v_exp_f32 v23, v31
s_waitcnt lgkmcnt(0)
s_cmp_lt_u32 s48, 2
s_cbranch_scc1 SM0_nr
s_add_u32 s54, s50, 16
v_cmp_ge_u32 vcc, s54, v127
s_bcnt1_i32_b64 s52, vcc
s_mul_i32 s53, s52, -4
s_mul_i32 s52, s52, 272
v_add_u32 v111, s52, v125
v_add3_u32 v110, v81, v124, s53
ds_read_b32 v85, v111 offset:0
ds_read_b32 v87, v111 offset:128
ds_read_b32 v81, v110
SM0_nr:
s_cmp_lt_u32 s49, 8
s_cbranch_scc1 SM0_C1
v_pk_add_f32 v[0:1], v[0:1], 1.0 op_sel_hi:[1,0]
v_pk_add_f32 v[16:17], v[16:17], 1.0 op_sel_hi:[1,0]
v_rcp_f32 v0, v0
v_rcp_f32 v1, v1
v_rcp_f32 v16, v16
v_rcp_f32 v17, v17
s_nop 0
v_pk_fma_f32 v[100:101], v[8:9], v[0:1], v[100:101]
v_pk_fma_f32 v[104:105], v[24:25], v[16:17], v[104:105]
v_pk_add_f32 v[2:3], v[2:3], 1.0 op_sel_hi:[1,0]
v_pk_add_f32 v[18:19], v[18:19], 1.0 op_sel_hi:[1,0]
v_rcp_f32 v2, v2
v_rcp_f32 v3, v3
v_rcp_f32 v18, v18
v_rcp_f32 v19, v19
s_nop 0
v_pk_fma_f32 v[100:101], v[10:11], v[2:3], v[100:101]
v_pk_fma_f32 v[104:105], v[26:27], v[18:19], v[104:105]
v_pk_add_f32 v[4:5], v[4:5], 1.0 op_sel_hi:[1,0]
v_pk_add_f32 v[20:21], v[20:21], 1.0 op_sel_hi:[1,0]
v_rcp_f32 v4, v4
v_rcp_f32 v5, v5
v_rcp_f32 v20, v20
v_rcp_f32 v21, v21
s_nop 0
v_pk_fma_f32 v[100:101], v[12:13], v[4:5], v[100:101]
v_pk_fma_f32 v[104:105], v[28:29], v[20:21], v[104:105]
v_pk_add_f32 v[6:7], v[6:7], 1.0 op_sel_hi:[1,0]
v_pk_add_f32 v[22:23], v[22:23], 1.0 op_sel_hi:[1,0]
v_rcp_f32 v6, v6
v_rcp_f32 v7, v7
v_rcp_f32 v22, v22
v_rcp_f32 v23, v23
s_nop 0
v_pk_fma_f32 v[100:101], v[14:15], v[6:7], v[100:101]
v_pk_fma_f32 v[104:105], v[30:31], v[22:23], v[104:105]
SM0_J1:
s_cmp_lt_u32 s48, 2
s_cbranch_scc1 SM0_nl
s_waitcnt vmcnt(0)
ds_read_b128 v[64:67], v120 offset:0
ds_read_b128 v[68:71], v121 offset:0
ds_read_b128 v[72:75], v120 offset:2048
ds_read_b128 v[76:79], v121 offset:2048
ds_read_u16 v116, v123 offset:768
ds_read_u16 v118, v123 offset:896
SM0_nl:
s_add_u32 s50, s50, 8
s_sub_u32 s49, s49, 8
s_sub_u32 s48, s48, 1
s_cmp_eq_u32 s48, 0
s_cbranch_scc1 SL1
SM1:
s_cmp_lt_u32 s48, 3
s_cbranch_scc1 SM1_lo
SM1_g:
s_waitcnt lgkmcnt(0)
s_mov_b32 m0, s56
s_nop 0
buffer_load_dwordx4 v[116:117], s[16:19], 0 idxen offen lds
s_mov_b32 m0, s57
s_nop 0
buffer_load_dwordx4 v[118:119], s[16:19], 0 idxen offen lds
s_mov_b32 m0, s58
s_nop 0
buffer_load_dwordx4 v[116:117], s[16:19], s60 idxen offen lds
s_mov_b32 m0, s59
s_nop 0
buffer_load_dwordx4 v[118:119], s[16:19], s60 idxen offen lds
SM1_ng:
v_mfma_f32_32x32x16_bf16 v[0:15], v[64:67], v[92:95], 0
v_exp_f32 v16, v32
v_exp_f32 v17, v33
v_exp_f32 v24, v48
v_exp_f32 v25, v49
v_mfma_f32_32x32x16_bf16 v[0:15], v[68:71], v[96:99], v[0:15]
v_exp_f32 v18, v34
v_exp_f32 v19, v35
v_exp_f32 v26, v50
v_exp_f32 v27, v51
v_mfma_f32_32x32x8_bf16 v[0:15], v[80:81], v[84:85], v[0:15]
v_exp_f32 v20, v36
v_exp_f32 v21, v37
v_exp_f32 v28, v52
v_exp_f32 v29, v53
v_exp_f32 v22, v38
v_exp_f32 v23, v39
v_exp_f32 v30, v54
v_exp_f32 v31, v55
s_cmp_lt_u32 s49, 4
s_cbranch_scc1 SM1_C0
v_pk_add_f32 v[16:17], v[16:17], 1.0 op_sel_hi:[1,0]
v_pk_add_f32 v[24:25], v[24:25], 1.0 op_sel_hi:[1,0]
v_rcp_f32 v16, v16
v_rcp_f32 v17, v17
v_rcp_f32 v24, v24
v_rcp_f32 v25, v25
s_nop 0
v_pk_fma_f32 v[100:101], v[32:33], v[16:17], v[100:101]
v_pk_fma_f32 v[104:105], v[48:49], v[24:25], v[104:105]
v_pk_add_f32 v[18:19], v[18:19], 1.0 op_sel_hi:[1,0]
v_pk_add_f32 v[26:27], v[26:27], 1.0 op_sel_hi:[1,0]
v_rcp_f32 v18, v18
v_rcp_f32 v19, v19
v_rcp_f32 v26, v26
v_rcp_f32 v27, v27
s_nop 0
v_pk_fma_f32 v[100:101], v[34:35], v[18:19], v[100:101]
v_pk_fma_f32 v[104:105], v[50:51], v[26:27], v[104:105]
v_pk_add_f32 v[20:21], v[20:21], 1.0 op_sel_hi:[1,0]
v_pk_add_f32 v[28:29], v[28:29], 1.0 op_sel_hi:[1,0]
v_rcp_f32 v20, v20
v_rcp_f32 v21, v21
v_rcp_f32 v28, v28
v_rcp_f32 v29, v29
s_nop 0
v_pk_fma_f32 v[100:101], v[36:37], v[20:21], v[100:101]
v_pk_fma_f32 v[104:105], v[52:53], v[28:29], v[104:105]
v_pk_add_f32 v[22:23], v[22:23], 1.0 op_sel_hi:[1,0]
v_pk_add_f32 v[30:31], v[30:31], 1.0 op_sel_hi:[1,0]
v_rcp_f32 v22, v22
v_rcp_f32 v23, v23
v_rcp_f32 v30, v30
v_rcp_f32 v31, v31
s_nop 0
v_pk_fma_f32 v[100:101], v[38:39], v[22:23], v[100:101]
v_pk_fma_f32 v[104:105], v[54:55], v[30:31], v[104:105]
SM1_J0:
ds_read_b64 v[82:83], v122 offset:768
v_mfma_f32_32x32x16_bf16 v[16:31], v[72:75], v[92:95], 0
v_exp_f32 v32, v40
v_exp_f32 v33, v41
v_exp_f32 v48, v56
v_exp_f32 v49, v57
v_mfma_f32_32x32x16_bf16 v[16:31], v[76:79], v[96:99], v[16:31]
v_exp_f32 v34, v42
v_exp_f32 v35, v43
v_exp_f32 v50, v58
v_exp_f32 v51, v59
v_mfma_f32_32x32x8_bf16 v[16:31], v[80:81], v[86:87], v[16:31]
v_exp_f32 v36, v44
v_exp_f32 v37, v45
v_exp_f32 v52, v60
v_exp_f32 v53, v61
v_exp_f32 v38, v46
v_exp_f32 v39, v47
v_exp_f32 v54, v62
v_exp_f32 v55, v63
s_waitcnt lgkmcnt(0)
s_cmp_lt_u32 s48, 2
s_cbranch_scc1 SM1_nr
s_add_u32 s54, s50, 16
v_cmp_ge_u32 vcc, s54, v127
s_bcnt1_i32_b64 s52, vcc
s_mul_i32 s53, s52, -4
s_mul_i32 s52, s52, 272
v_add_u32 v111, s52, v125
v_add3_u32 v110, v83, v124, s53
ds_read_b32 v85, v111 offset:0
ds_read_b32 v87, v111 offset:128
ds_read_b32 v83, v110
SM1_nr:
s_cmp_lt_u32 s49, 8
s_cbranch_scc1 SM1_C1
v_pk_add_f32 v[32:33], v[32:33], 1.0 op_sel_hi:[1,0]
v_pk_add_f32 v[48:49], v[48:49], 1.0 op_sel_hi:[1,0]
v_rcp_f32 v32, v32
v_rcp_f32 v33, v33
v_rcp_f32 v48, v48
v_rcp_f32 v49, v49
s_nop 0
v_pk_fma_f32 v[100:101], v[40:41], v[32:33], v[100:101]
v_pk_fma_f32 v[104:105], v[56:57], v[48:49], v[104:105]
v_pk_add_f32 v[34:35], v[34:35], 1.0 op_sel_hi:[1,0]
v_pk_add_f32 v[50:51], v[50:51], 1.0 op_sel_hi:[1,0]
v_rcp_f32 v34, v34
v_rcp_f32 v35, v35
v_rcp_f32 v50, v50
v_rcp_f32 v51, v51
s_nop 0
v_pk_fma_f32 v[100:101], v[42:43], v[34:35], v[100:101]
v_pk_fma_f32 v[104:105], v[58:59], v[50:51], v[104:105]
v_pk_add_f32 v[36:37], v[36:37], 1.0 op_sel_hi:[1,0]
v_pk_add_f32 v[52:53], v[52:53], 1.0 op_sel_hi:[1,0]
v_rcp_f32 v36, v36
v_rcp_f32 v37, v37
v_rcp_f32 v52, v52
v_rcp_f32 v53, v53
s_nop 0
v_pk_fma_f32 v[100:101], v[44:45], v[36:37], v[100:101]
v_pk_fma_f32 v[104:105], v[60:61], v[52:53], v[104:105]
v_pk_add_f32 v[38:39], v[38:39], 1.0 op_sel_hi:[1,0]
v_pk_add_f32 v[54:55], v[54:55], 1.0 op_sel_hi:[1,0]
v_rcp_f32 v38, v38
v_rcp_f32 v39, v39
v_rcp_f32 v54, v54
v_rcp_f32 v55, v55
s_nop 0
v_pk_fma_f32 v[100:101], v[46:47], v[38:39], v[100:101]
v_pk_fma_f32 v[104:105], v[62:63], v[54:55], v[104:105]
SM1_J1:
s_cmp_lt_u32 s48, 2
s_cbranch_scc1 SM1_nl
s_waitcnt vmcnt(0)
ds_read_b128 v[64:67], v120 offset:0
ds_read_b128 v[68:71], v121 offset:0
ds_read_b128 v[72:75], v120 offset:2048
ds_read_b128 v[76:79], v121 offset:2048
ds_read_u16 v116, v123 offset:1024
ds_read_u16 v118, v123 offset:1152
SM1_nl:
v_add_u32 v122, 512, v122
v_add_u32 v123, 512, v123
s_add_u32 s50, s50, 8
s_sub_u32 s49, s49, 8
s_sub_u32 s48, s48, 1
s_cmp_eq_u32 s48, 0
s_cbranch_scc1 SL0
s_branch SM0
SL0:
s_setprio 1
s_waitcnt lgkmcnt(0)
s_mov_b32 m0, 0
s_lshl_b32 s52, s65, 7
ds_read_addtid_b32 v124 offset:41600
ds_read_addtid_b32 v88 offset:41856
ds_read_addtid_b32 v120 offset:42112
ds_read_addtid_b32 v121 offset:42368
ds_read_addtid_b32 v122 offset:42624
ds_read_addtid_b32 v123 offset:42880
ds_read_addtid_b32 v125 offset:43136
ds_read_addtid_b32 v90 offset:43392
ds_read_addtid_b32 v91 offset:43648
s_waitcnt lgkmcnt(7)
v_add_u32 v88, s52, v88
s_mov_b32 m0, s56
s_add_u32 s52, s61, 0
buffer_load_dwordx4 v124, s[72:75], s52 offen lds
s_mov_b32 m0, s57
s_add_u32 s52, s61, 4096
buffer_load_dwordx4 v124, s[72:75], s52 offen lds
s_mov_b32 m0, s58
s_add_u32 s52, s61, 8192
buffer_load_dwordx4 v124, s[72:75], s52 offen lds
s_mov_b32 m0, s59
s_add_u32 s52, s61, 12288
buffer_load_dwordx4 v124, s[72:75], s52 offen lds
v_xor_b32 v89, 64, v88
ds_read_b128 v[64:67], v88 offset:61312
ds_read_b128 v[68:71], v89 offset:61312
s_mul_i32 s52, s28, 2112
s_add_u32 s52, s52, 69504
s_mul_i32 s53, s28, 576
s_add_u32 s53, s53, 96000
s_waitcnt lgkmcnt(2)
v_add_u32 v120, s52, v120
v_add_u32 v121, s53, v121
s_mul_i32 s52, s65, 144
s_add_u32 s52, s52, 96000
s_add_u32 s53, s52, s61
v_add_u32 v122, s52, v122
v_add_u32 v123, s53, v123
s_mul_i32 s52, s28, 1152
s_add_u32 s52, s52, 96000
s_lshl_b32 s53, s28, 11
s_add_u32 s53, s53, s64
s_lshl_b32 s53, s53, 7
v_add_u32 v90, s52, v90
v_add_u32 v91, s53, v91
v_add_u32 v125, s56, v125
v_exp_f32 v48, v0
v_exp_f32 v49, v1
v_exp_f32 v56, v16
v_exp_f32 v57, v17
v_exp_f32 v50, v2
v_exp_f32 v51, v3
v_exp_f32 v58, v18
v_exp_f32 v59, v19
v_exp_f32 v52, v4
v_exp_f32 v53, v5
v_exp_f32 v60, v20
v_exp_f32 v61, v21
v_exp_f32 v54, v6
v_exp_f32 v55, v7
v_exp_f32 v62, v22
v_exp_f32 v63, v23
s_cmp_lt_u32 s49, 4
s_cbranch_scc1 SL0_C0
v_pk_add_f32 v[48:49], v[48:49], 1.0 op_sel_hi:[1,0]
v_pk_add_f32 v[56:57], v[56:57], 1.0 op_sel_hi:[1,0]
v_rcp_f32 v48, v48
v_rcp_f32 v49, v49
v_rcp_f32 v56, v56
v_rcp_f32 v57, v57
s_nop 0
v_pk_fma_f32 v[100:101], v[0:1], v[48:49], v[100:101]
v_pk_fma_f32 v[104:105], v[16:17], v[56:57], v[104:105]
v_pk_add_f32 v[50:51], v[50:51], 1.0 op_sel_hi:[1,0]
v_pk_add_f32 v[58:59], v[58:59], 1.0 op_sel_hi:[1,0]
v_rcp_f32 v50, v50
v_rcp_f32 v51, v51
v_rcp_f32 v58, v58
v_rcp_f32 v59, v59
s_nop 0
v_pk_fma_f32 v[100:101], v[2:3], v[50:51], v[100:101]
v_pk_fma_f32 v[104:105], v[18:19], v[58:59], v[104:105]
v_pk_add_f32 v[52:53], v[52:53], 1.0 op_sel_hi:[1,0]
v_pk_add_f32 v[60:61], v[60:61], 1.0 op_sel_hi:[1,0]
v_rcp_f32 v52, v52
v_rcp_f32 v53, v53
v_rcp_f32 v60, v60
v_rcp_f32 v61, v61
s_nop 0
v_pk_fma_f32 v[100:101], v[4:5], v[52:53], v[100:101]
v_pk_fma_f32 v[104:105], v[20:21], v[60:61], v[104:105]
v_pk_add_f32 v[54:55], v[54:55], 1.0 op_sel_hi:[1,0]
v_pk_add_f32 v[62:63], v[62:63], 1.0 op_sel_hi:[1,0]
v_rcp_f32 v54, v54
v_rcp_f32 v55, v55
v_rcp_f32 v62, v62
v_rcp_f32 v63, v63
s_nop 0
v_pk_fma_f32 v[100:101], v[6:7], v[54:55], v[100:101]
v_pk_fma_f32 v[104:105], v[22:23], v[62:63], v[104:105]
SL0_J0:
s_setprio 0
s_waitcnt vmcnt(0)
ds_read_b64_tr_b16 v[72:73], v125 offset:0
ds_read_b64_tr_b16 v[74:75], v125 offset:128
ds_read_b64_tr_b16 v[76:77], v125 offset:1024
ds_read_b64_tr_b16 v[78:79], v125 offset:1152
ds_read_b64_tr_b16 v[80:81], v125 offset:2048
ds_read_b64_tr_b16 v[82:83], v125 offset:2176
ds_read_b64_tr_b16 v[84:85], v125 offset:3072
ds_read_b64_tr_b16 v[86:87], v125 offset:3200
s_cmp_lg_u32 s82, 0
s_cbranch_scc1 S_hfin
v_exp_f32 v0, v8
v_exp_f32 v1, v9
v_exp_f32 v16, v24
v_exp_f32 v17, v25
v_exp_f32 v2, v10
v_exp_f32 v3, v11
v_exp_f32 v18, v26
v_exp_f32 v19, v27
v_exp_f32 v4, v12
v_exp_f32 v5, v13
s_waitcnt lgkmcnt(0)
v_mfma_f32_16x16x32_bf16 v[116:119], v[72:75], v[64:67], 0
v_mfma_f32_16x16x32_bf16 v[116:119], v[76:79], v[68:71], v[116:119]
v_exp_f32 v20, v28
v_exp_f32 v21, v29
v_exp_f32 v6, v14
v_exp_f32 v7, v15
v_exp_f32 v22, v30
v_exp_f32 v23, v31
s_cmp_lt_u32 s49, 8
s_cbranch_scc1 SL0_C1
v_pk_add_f32 v[0:1], v[0:1], 1.0 op_sel_hi:[1,0]
v_pk_add_f32 v[16:17], v[16:17], 1.0 op_sel_hi:[1,0]
v_rcp_f32 v0, v0
v_rcp_f32 v1, v1
v_rcp_f32 v16, v16
v_rcp_f32 v17, v17
s_nop 0
v_pk_fma_f32 v[100:101], v[8:9], v[0:1], v[100:101]
v_pk_fma_f32 v[104:105], v[24:25], v[16:17], v[104:105]
v_pk_add_f32 v[2:3], v[2:3], 1.0 op_sel_hi:[1,0]
v_pk_add_f32 v[18:19], v[18:19], 1.0 op_sel_hi:[1,0]
v_rcp_f32 v2, v2
v_rcp_f32 v3, v3
v_rcp_f32 v18, v18
v_rcp_f32 v19, v19
s_nop 0
v_pk_fma_f32 v[100:101], v[10:11], v[2:3], v[100:101]
v_pk_fma_f32 v[104:105], v[26:27], v[18:19], v[104:105]
v_pk_add_f32 v[4:5], v[4:5], 1.0 op_sel_hi:[1,0]
v_pk_add_f32 v[20:21], v[20:21], 1.0 op_sel_hi:[1,0]
v_rcp_f32 v4, v4
v_rcp_f32 v5, v5
v_rcp_f32 v20, v20
v_rcp_f32 v21, v21
s_nop 0
v_pk_fma_f32 v[100:101], v[12:13], v[4:5], v[100:101]
v_pk_fma_f32 v[104:105], v[28:29], v[20:21], v[104:105]
v_pk_add_f32 v[6:7], v[6:7], 1.0 op_sel_hi:[1,0]
v_pk_add_f32 v[22:23], v[22:23], 1.0 op_sel_hi:[1,0]
v_rcp_f32 v6, v6
v_rcp_f32 v7, v7
v_rcp_f32 v22, v22
v_rcp_f32 v23, v23
s_nop 0
v_pk_fma_f32 v[100:101], v[14:15], v[6:7], v[100:101]
v_pk_fma_f32 v[104:105], v[30:31], v[22:23], v[104:105]
SL0_J1:
s_branch S_fin
SL1n:
s_nop 15
SL1:
s_setprio 1
s_waitcnt lgkmcnt(0)
s_mov_b32 m0, 0
s_lshl_b32 s52, s65, 7
ds_read_addtid_b32 v124 offset:41600
ds_read_addtid_b32 v88 offset:41856
ds_read_addtid_b32 v120 offset:42112
ds_read_addtid_b32 v121 offset:42368
ds_read_addtid_b32 v122 offset:42624
ds_read_addtid_b32 v123 offset:42880
ds_read_addtid_b32 v125 offset:43136
ds_read_addtid_b32 v90 offset:43392
ds_read_addtid_b32 v91 offset:43648
s_waitcnt lgkmcnt(7)
v_add_u32 v88, s52, v88
s_mov_b32 m0, s56
s_add_u32 s52, s61, 0
buffer_load_dwordx4 v124, s[72:75], s52 offen lds
s_mov_b32 m0, s57
s_add_u32 s52, s61, 4096
buffer_load_dwordx4 v124, s[72:75], s52 offen lds
s_mov_b32 m0, s58
s_add_u32 s52, s61, 8192
buffer_load_dwordx4 v124, s[72:75], s52 offen lds
s_mov_b32 m0, s59
s_add_u32 s52, s61, 12288
buffer_load_dwordx4 v124, s[72:75], s52 offen lds
v_xor_b32 v89, 64, v88
ds_read_b128 v[64:67], v88 offset:61312
ds_read_b128 v[68:71], v89 offset:61312
s_mul_i32 s52, s28, 2112
s_add_u32 s52, s52, 69504
s_mul_i32 s53, s28, 576
s_add_u32 s53, s53, 96000
s_waitcnt lgkmcnt(2)
v_add_u32 v120, s52, v120
v_add_u32 v121, s53, v121
s_mul_i32 s52, s65, 144
s_add_u32 s52, s52, 96000
s_add_u32 s53, s52, s61
v_add_u32 v122, s52, v122
v_add_u32 v123, s53, v123
s_mul_i32 s52, s28, 1152
s_add_u32 s52, s52, 96000
s_lshl_b32 s53, s28, 11
s_add_u32 s53, s53, s64
s_lshl_b32 s53, s53, 7
v_add_u32 v90, s52, v90
v_add_u32 v91, s53, v91
v_add_u32 v125, s56, v125
v_exp_f32 v16, v32
v_exp_f32 v17, v33
v_exp_f32 v24, v48
v_exp_f32 v25, v49
v_exp_f32 v18, v34
v_exp_f32 v19, v35
v_exp_f32 v26, v50
v_exp_f32 v27, v51
v_exp_f32 v20, v36
v_exp_f32 v21, v37
v_exp_f32 v28, v52
v_exp_f32 v29, v53
v_exp_f32 v22, v38
v_exp_f32 v23, v39
v_exp_f32 v30, v54
v_exp_f32 v31, v55
s_cmp_lt_u32 s49, 4
s_cbranch_scc1 SL1_C0
v_pk_add_f32 v[16:17], v[16:17], 1.0 op_sel_hi:[1,0]
v_pk_add_f32 v[24:25], v[24:25], 1.0 op_sel_hi:[1,0]
v_rcp_f32 v16, v16
v_rcp_f32 v17, v17
v_rcp_f32 v24, v24
v_rcp_f32 v25, v25
s_nop 0
v_pk_fma_f32 v[100:101], v[32:33], v[16:17], v[100:101]
v_pk_fma_f32 v[104:105], v[48:49], v[24:25], v[104:105]
v_pk_add_f32 v[18:19], v[18:19], 1.0 op_sel_hi:[1,0]
v_pk_add_f32 v[26:27], v[26:27], 1.0 op_sel_hi:[1,0]
v_rcp_f32 v18, v18
v_rcp_f32 v19, v19
v_rcp_f32 v26, v26
v_rcp_f32 v27, v27
s_nop 0
v_pk_fma_f32 v[100:101], v[34:35], v[18:19], v[100:101]
v_pk_fma_f32 v[104:105], v[50:51], v[26:27], v[104:105]
v_pk_add_f32 v[20:21], v[20:21], 1.0 op_sel_hi:[1,0]
v_pk_add_f32 v[28:29], v[28:29], 1.0 op_sel_hi:[1,0]
v_rcp_f32 v20, v20
v_rcp_f32 v21, v21
v_rcp_f32 v28, v28
v_rcp_f32 v29, v29
s_nop 0
v_pk_fma_f32 v[100:101], v[36:37], v[20:21], v[100:101]
v_pk_fma_f32 v[104:105], v[52:53], v[28:29], v[104:105]
v_pk_add_f32 v[22:23], v[22:23], 1.0 op_sel_hi:[1,0]
v_pk_add_f32 v[30:31], v[30:31], 1.0 op_sel_hi:[1,0]
v_rcp_f32 v22, v22
v_rcp_f32 v23, v23
v_rcp_f32 v30, v30
v_rcp_f32 v31, v31
s_nop 0
v_pk_fma_f32 v[100:101], v[38:39], v[22:23], v[100:101]
v_pk_fma_f32 v[104:105], v[54:55], v[30:31], v[104:105]
SL1_J0:
s_setprio 0
s_waitcnt vmcnt(0)
ds_read_b64_tr_b16 v[72:73], v125 offset:0
ds_read_b64_tr_b16 v[74:75], v125 offset:128
ds_read_b64_tr_b16 v[76:77], v125 offset:1024
ds_read_b64_tr_b16 v[78:79], v125 offset:1152
ds_read_b64_tr_b16 v[80:81], v125 offset:2048
ds_read_b64_tr_b16 v[82:83], v125 offset:2176
ds_read_b64_tr_b16 v[84:85], v125 offset:3072
ds_read_b64_tr_b16 v[86:87], v125 offset:3200
s_cmp_lg_u32 s82, 0
s_cbranch_scc1 S_hfin
v_exp_f32 v32, v40
v_exp_f32 v33, v41
v_exp_f32 v48, v56
v_exp_f32 v49, v57
v_exp_f32 v34, v42
v_exp_f32 v35, v43
v_exp_f32 v50, v58
v_exp_f32 v51, v59
v_exp_f32 v36, v44
v_exp_f32 v37, v45
s_waitcnt lgkmcnt(0)
v_mfma_f32_16x16x32_bf16 v[116:119], v[72:75], v[64:67], 0
v_mfma_f32_16x16x32_bf16 v[116:119], v[76:79], v[68:71], v[116:119]
v_exp_f32 v52, v60
v_exp_f32 v53, v61
v_exp_f32 v38, v46
v_exp_f32 v39, v47
v_exp_f32 v54, v62
v_exp_f32 v55, v63
s_cmp_lt_u32 s49, 8
s_cbranch_scc1 SL1_C1
v_pk_add_f32 v[32:33], v[32:33], 1.0 op_sel_hi:[1,0]
v_pk_add_f32 v[48:49], v[48:49], 1.0 op_sel_hi:[1,0]
v_rcp_f32 v32, v32
v_rcp_f32 v33, v33
v_rcp_f32 v48, v48
v_rcp_f32 v49, v49
s_nop 0
v_pk_fma_f32 v[100:101], v[40:41], v[32:33], v[100:101]
v_pk_fma_f32 v[104:105], v[56:57], v[48:49], v[104:105]
v_pk_add_f32 v[34:35], v[34:35], 1.0 op_sel_hi:[1,0]
v_pk_add_f32 v[50:51], v[50:51], 1.0 op_sel_hi:[1,0]
v_rcp_f32 v34, v34
v_rcp_f32 v35, v35
v_rcp_f32 v50, v50
v_rcp_f32 v51, v51
s_nop 0
v_pk_fma_f32 v[100:101], v[42:43], v[34:35], v[100:101]
v_pk_fma_f32 v[104:105], v[58:59], v[50:51], v[104:105]
v_pk_add_f32 v[36:37], v[36:37], 1.0 op_sel_hi:[1,0]
v_pk_add_f32 v[52:53], v[52:53], 1.0 op_sel_hi:[1,0]
v_rcp_f32 v36, v36
v_rcp_f32 v37, v37
v_rcp_f32 v52, v52
v_rcp_f32 v53, v53
s_nop 0
v_pk_fma_f32 v[100:101], v[44:45], v[36:37], v[100:101]
v_pk_fma_f32 v[104:105], v[60:61], v[52:53], v[104:105]
v_pk_add_f32 v[38:39], v[38:39], 1.0 op_sel_hi:[1,0]
v_pk_add_f32 v[54:55], v[54:55], 1.0 op_sel_hi:[1,0]
v_rcp_f32 v38, v38
v_rcp_f32 v39, v39
v_rcp_f32 v54, v54
v_rcp_f32 v55, v55
s_nop 0
v_pk_fma_f32 v[100:101], v[46:47], v[38:39], v[100:101]
v_pk_fma_f32 v[104:105], v[62:63], v[54:55], v[104:105]
SL1_J1:
S_fin:
v_add_f32 v112, v100, v101
v_add_f32 v113, v104, v105
v_cvt_f64_f32 v[110:111], v112
v_cvt_f64_f32 v[114:115], v113
ds_add_f64 v126, v[110:111]
ds_add_f64 v126, v[114:115] offset:256
s_branch K2_join
S_hfin:
v_add_f32 v112, v100, v101
v_add_f32 v113, v104, v105
v_cvt_f64_f32 v[110:111], v112
v_cvt_f64_f32 v[114:115], v113
ds_add_f64 v126, v[110:111]
ds_add_f64 v126, v[114:115] offset:256
s_waitcnt lgkmcnt(0)
v_mfma_f32_16x16x32_bf16 v[116:119], v[72:75], v[64:67], 0
v_mfma_f32_16x16x32_bf16 v[116:119], v[76:79], v[68:71], v[116:119]
s_branch K2_join
SM0_lo:
s_nop 0
s_cmp_eq_u32 s48, 2
s_cbranch_scc1 SM0_g
s_setprio 2
s_waitcnt lgkmcnt(0)
s_branch SM0_ng
SM0_C0:
s_cmp_eq_u32 s49, 0
s_cbranch_scc1 SM0_F0
v_pk_add_f32 v[48:49], v[48:49], 1.0 op_sel_hi:[1,0]
v_pk_add_f32 v[56:57], v[56:57], 1.0 op_sel_hi:[1,0]
v_rcp_f32 v48, v48
v_rcp_f32 v49, v49
v_rcp_f32 v56, v56
v_rcp_f32 v57, v57
s_nop 0
v_pk_fma_f32 v[100:101], v[0:1], v[48:49], v[100:101]
v_pk_fma_f32 v[104:105], v[16:17], v[56:57], v[104:105]
SM0_A0:
s_cmp_eq_u32 s49, 1
s_cbranch_scc1 SM0_F1
v_pk_add_f32 v[50:51], v[50:51], 1.0 op_sel_hi:[1,0]
v_pk_add_f32 v[58:59], v[58:59], 1.0 op_sel_hi:[1,0]
v_rcp_f32 v50, v50
v_rcp_f32 v51, v51
v_rcp_f32 v58, v58
v_rcp_f32 v59, v59
s_nop 0
v_pk_fma_f32 v[100:101], v[2:3], v[50:51], v[100:101]
v_pk_fma_f32 v[104:105], v[18:19], v[58:59], v[104:105]
SM0_A1:
s_cmp_eq_u32 s49, 2
s_cbranch_scc1 SM0_F2
v_pk_add_f32 v[52:53], v[52:53], 1.0 op_sel_hi:[1,0]
v_pk_add_f32 v[60:61], v[60:61], 1.0 op_sel_hi:[1,0]
v_rcp_f32 v52, v52
v_rcp_f32 v53, v53
v_rcp_f32 v60, v60
v_rcp_f32 v61, v61
s_nop 0
v_pk_fma_f32 v[100:101], v[4:5], v[52:53], v[100:101]
v_pk_fma_f32 v[104:105], v[20:21], v[60:61], v[104:105]
SM0_A2:
s_cmp_eq_u32 s49, 3
s_cbranch_scc1 SM0_F3
v_pk_add_f32 v[54:55], v[54:55], 1.0 op_sel_hi:[1,0]
v_pk_add_f32 v[62:63], v[62:63], 1.0 op_sel_hi:[1,0]
v_rcp_f32 v54, v54
v_rcp_f32 v55, v55
v_rcp_f32 v62, v62
v_rcp_f32 v63, v63
s_nop 0
v_pk_fma_f32 v[100:101], v[6:7], v[54:55], v[100:101]
v_pk_fma_f32 v[104:105], v[22:23], v[62:63], v[104:105]
s_branch SM0_J0
SM0_C1:
s_cmp_eq_u32 s49, 4
s_cbranch_scc1 SM0_F4
v_pk_add_f32 v[0:1], v[0:1], 1.0 op_sel_hi:[1,0]
v_pk_add_f32 v[16:17], v[16:17], 1.0 op_sel_hi:[1,0]
v_rcp_f32 v0, v0
v_rcp_f32 v1, v1
v_rcp_f32 v16, v16
v_rcp_f32 v17, v17
s_nop 0
v_pk_fma_f32 v[100:101], v[8:9], v[0:1], v[100:101]
v_pk_fma_f32 v[104:105], v[24:25], v[16:17], v[104:105]
SM0_A4:
s_cmp_eq_u32 s49, 5
s_cbranch_scc1 SM0_F5
v_pk_add_f32 v[2:3], v[2:3], 1.0 op_sel_hi:[1,0]
v_pk_add_f32 v[18:19], v[18:19], 1.0 op_sel_hi:[1,0]
v_rcp_f32 v2, v2
v_rcp_f32 v3, v3
v_rcp_f32 v18, v18
v_rcp_f32 v19, v19
s_nop 0
v_pk_fma_f32 v[100:101], v[10:11], v[2:3], v[100:101]
v_pk_fma_f32 v[104:105], v[26:27], v[18:19], v[104:105]
SM0_A5:
s_cmp_eq_u32 s49, 6
s_cbranch_scc1 SM0_F6
v_pk_add_f32 v[4:5], v[4:5], 1.0 op_sel_hi:[1,0]
v_pk_add_f32 v[20:21], v[20:21], 1.0 op_sel_hi:[1,0]
v_rcp_f32 v4, v4
v_rcp_f32 v5, v5
v_rcp_f32 v20, v20
v_rcp_f32 v21, v21
s_nop 0
v_pk_fma_f32 v[100:101], v[12:13], v[4:5], v[100:101]
v_pk_fma_f32 v[104:105], v[28:29], v[20:21], v[104:105]
SM0_A6:
s_cmp_eq_u32 s49, 7
s_cbranch_scc1 SM0_F7
v_pk_add_f32 v[6:7], v[6:7], 1.0 op_sel_hi:[1,0]
v_pk_add_f32 v[22:23], v[22:23], 1.0 op_sel_hi:[1,0]
v_rcp_f32 v6, v6
v_rcp_f32 v7, v7
v_rcp_f32 v22, v22
v_rcp_f32 v23, v23
s_nop 0
v_pk_fma_f32 v[100:101], v[14:15], v[6:7], v[100:101]
v_pk_fma_f32 v[104:105], v[30:31], v[22:23], v[104:105]
s_branch SM0_J1
SM0_F0:
s_add_u32 s51, s51, 1
v_readlane_b32 s52, v127, s51
v_add_f32 v112, v100, v101
v_add_f32 v113, v104, v105
v_cvt_f64_f32 v[110:111], v112
v_cvt_f64_f32 v[114:115], v113
ds_add_f64 v126, v[110:111]
ds_add_f64 v126, v[114:115] offset:256
v_add_u32 v126, 528, v126
s_sub_u32 s49, s52, s50
v_mov_b32 v100, 0
v_mov_b32 v101, 0
v_mov_b32 v104, 0
v_mov_b32 v105, 0
v_pk_add_f32 v[48:49], v[48:49], 1.0 op_sel_hi:[1,0]
v_pk_add_f32 v[56:57], v[56:57], 1.0 op_sel_hi:[1,0]
v_rcp_f32 v48, v48
v_rcp_f32 v49, v49
v_rcp_f32 v56, v56
v_rcp_f32 v57, v57
s_nop 0
v_pk_fma_f32 v[100:101], v[0:1], v[48:49], v[100:101]
v_pk_fma_f32 v[104:105], v[16:17], v[56:57], v[104:105]
s_branch SM0_A0
SM0_F1:
s_add_u32 s51, s51, 1
v_readlane_b32 s52, v127, s51
v_add_f32 v112, v100, v101
v_add_f32 v113, v104, v105
v_cvt_f64_f32 v[110:111], v112
v_cvt_f64_f32 v[114:115], v113
ds_add_f64 v126, v[110:111]
ds_add_f64 v126, v[114:115] offset:256
v_add_u32 v126, 528, v126
s_sub_u32 s49, s52, s50
v_mov_b32 v100, 0
v_mov_b32 v101, 0
v_mov_b32 v104, 0
v_mov_b32 v105, 0
v_pk_add_f32 v[50:51], v[50:51], 1.0 op_sel_hi:[1,0]
v_pk_add_f32 v[58:59], v[58:59], 1.0 op_sel_hi:[1,0]
v_rcp_f32 v50, v50
v_rcp_f32 v51, v51
v_rcp_f32 v58, v58
v_rcp_f32 v59, v59
s_nop 0
v_pk_fma_f32 v[100:101], v[2:3], v[50:51], v[100:101]
v_pk_fma_f32 v[104:105], v[18:19], v[58:59], v[104:105]
s_branch SM0_A1
SM0_F2:
s_add_u32 s51, s51, 1
v_readlane_b32 s52, v127, s51
v_add_f32 v112, v100, v101
v_add_f32 v113, v104, v105
v_cvt_f64_f32 v[110:111], v112
v_cvt_f64_f32 v[114:115], v113
ds_add_f64 v126, v[110:111]
ds_add_f64 v126, v[114:115] offset:256
v_add_u32 v126, 528, v126
s_sub_u32 s49, s52, s50
v_mov_b32 v100, 0
v_mov_b32 v101, 0
v_mov_b32 v104, 0
v_mov_b32 v105, 0
v_pk_add_f32 v[52:53], v[52:53], 1.0 op_sel_hi:[1,0]
v_pk_add_f32 v[60:61], v[60:61], 1.0 op_sel_hi:[1,0]
v_rcp_f32 v52, v52
v_rcp_f32 v53, v53
v_rcp_f32 v60, v60
v_rcp_f32 v61, v61
s_nop 0
v_pk_fma_f32 v[100:101], v[4:5], v[52:53], v[100:101]
v_pk_fma_f32 v[104:105], v[20:21], v[60:61], v[104:105]
s_branch SM0_A2
SM0_F3:
s_add_u32 s51, s51, 1
v_readlane_b32 s52, v127, s51
v_add_f32 v112, v100, v101
v_add_f32 v113, v104, v105
v_cvt_f64_f32 v[110:111], v112
v_cvt_f64_f32 v[114:115], v113
ds_add_f64 v126, v[110:111]
ds_add_f64 v126, v[114:115] offset:256
v_add_u32 v126, 528, v126
s_sub_u32 s49, s52, s50
v_mov_b32 v100, 0
v_mov_b32 v101, 0
v_mov_b32 v104, 0
v_mov_b32 v105, 0
v_pk_add_f32 v[54:55], v[54:55], 1.0 op_sel_hi:[1,0]
v_pk_add_f32 v[62:63], v[62:63], 1.0 op_sel_hi:[1,0]
v_rcp_f32 v54, v54
v_rcp_f32 v55, v55
v_rcp_f32 v62, v62
v_rcp_f32 v63, v63
s_nop 0
v_pk_fma_f32 v[100:101], v[6:7], v[54:55], v[100:101]
v_pk_fma_f32 v[104:105], v[22:23], v[62:63], v[104:105]
s_branch SM0_J0
SM0_F4:
s_add_u32 s51, s51, 1
v_readlane_b32 s52, v127, s51
v_add_f32 v112, v100, v101
v_add_f32 v113, v104, v105
v_cvt_f64_f32 v[110:111], v112
v_cvt_f64_f32 v[114:115], v113
ds_add_f64 v126, v[110:111]
ds_add_f64 v126, v[114:115] offset:256
v_add_u32 v126, 528, v126
s_sub_u32 s49, s52, s50
v_mov_b32 v100, 0
v_mov_b32 v101, 0
v_mov_b32 v104, 0
v_mov_b32 v105, 0
v_pk_add_f32 v[0:1], v[0:1], 1.0 op_sel_hi:[1,0]
v_pk_add_f32 v[16:17], v[16:17], 1.0 op_sel_hi:[1,0]
v_rcp_f32 v0, v0
v_rcp_f32 v1, v1
v_rcp_f32 v16, v16
v_rcp_f32 v17, v17
s_nop 0
v_pk_fma_f32 v[100:101], v[8:9], v[0:1], v[100:101]
v_pk_fma_f32 v[104:105], v[24:25], v[16:17], v[104:105]
s_branch SM0_A4
SM0_F5:
s_add_u32 s51, s51, 1
v_readlane_b32 s52, v127, s51
v_add_f32 v112, v100, v101
v_add_f32 v113, v104, v105
v_cvt_f64_f32 v[110:111], v112
v_cvt_f64_f32 v[114:115], v113
ds_add_f64 v126, v[110:111]
ds_add_f64 v126, v[114:115] offset:256
v_add_u32 v126, 528, v126
s_sub_u32 s49, s52, s50
v_mov_b32 v100, 0
v_mov_b32 v101, 0
v_mov_b32 v104, 0
v_mov_b32 v105, 0
v_pk_add_f32 v[2:3], v[2:3], 1.0 op_sel_hi:[1,0]
v_pk_add_f32 v[18:19], v[18:19], 1.0 op_sel_hi:[1,0]
v_rcp_f32 v2, v2
v_rcp_f32 v3, v3
v_rcp_f32 v18, v18
v_rcp_f32 v19, v19
s_nop 0
v_pk_fma_f32 v[100:101], v[10:11], v[2:3], v[100:101]
v_pk_fma_f32 v[104:105], v[26:27], v[18:19], v[104:105]
s_branch SM0_A5
SM0_F6:
s_add_u32 s51, s51, 1
v_readlane_b32 s52, v127, s51
v_add_f32 v112, v100, v101
v_add_f32 v113, v104, v105
v_cvt_f64_f32 v[110:111], v112
v_cvt_f64_f32 v[114:115], v113
ds_add_f64 v126, v[110:111]
ds_add_f64 v126, v[114:115] offset:256
v_add_u32 v126, 528, v126
s_sub_u32 s49, s52, s50
v_mov_b32 v100, 0
v_mov_b32 v101, 0
v_mov_b32 v104, 0
v_mov_b32 v105, 0
v_pk_add_f32 v[4:5], v[4:5], 1.0 op_sel_hi:[1,0]
v_pk_add_f32 v[20:21], v[20:21], 1.0 op_sel_hi:[1,0]
v_rcp_f32 v4, v4
v_rcp_f32 v5, v5
v_rcp_f32 v20, v20
v_rcp_f32 v21, v21
s_nop 0
v_pk_fma_f32 v[100:101], v[12:13], v[4:5], v[100:101]
v_pk_fma_f32 v[104:105], v[28:29], v[20:21], v[104:105]
s_branch SM0_A6
SM0_F7:
s_add_u32 s51, s51, 1
v_readlane_b32 s52, v127, s51
v_add_f32 v112, v100, v101
v_add_f32 v113, v104, v105
v_cvt_f64_f32 v[110:111], v112
v_cvt_f64_f32 v[114:115], v113
ds_add_f64 v126, v[110:111]
ds_add_f64 v126, v[114:115] offset:256
v_add_u32 v126, 528, v126
s_sub_u32 s49, s52, s50
v_mov_b32 v100, 0
v_mov_b32 v101, 0
v_mov_b32 v104, 0
v_mov_b32 v105, 0
v_pk_add_f32 v[6:7], v[6:7], 1.0 op_sel_hi:[1,0]
v_pk_add_f32 v[22:23], v[22:23], 1.0 op_sel_hi:[1,0]
v_rcp_f32 v6, v6
v_rcp_f32 v7, v7
v_rcp_f32 v22, v22
v_rcp_f32 v23, v23
s_nop 0
v_pk_fma_f32 v[100:101], v[14:15], v[6:7], v[100:101]
v_pk_fma_f32 v[104:105], v[30:31], v[22:23], v[104:105]
s_branch SM0_J1
SM1_lo:
s_nop 0
s_cmp_eq_u32 s48, 2
s_cbranch_scc1 SM1_g
s_setprio 2
s_waitcnt lgkmcnt(0)
s_branch SM1_ng
SM1_C0:
s_cmp_eq_u32 s49, 0
s_cbranch_scc1 SM1_F0
v_pk_add_f32 v[16:17], v[16:17], 1.0 op_sel_hi:[1,0]
v_pk_add_f32 v[24:25], v[24:25], 1.0 op_sel_hi:[1,0]
v_rcp_f32 v16, v16
v_rcp_f32 v17, v17
v_rcp_f32 v24, v24
v_rcp_f32 v25, v25
s_nop 0
v_pk_fma_f32 v[100:101], v[32:33], v[16:17], v[100:101]
v_pk_fma_f32 v[104:105], v[48:49], v[24:25], v[104:105]
SM1_A0:
s_cmp_eq_u32 s49, 1
s_cbranch_scc1 SM1_F1
v_pk_add_f32 v[18:19], v[18:19], 1.0 op_sel_hi:[1,0]
v_pk_add_f32 v[26:27], v[26:27], 1.0 op_sel_hi:[1,0]
v_rcp_f32 v18, v18
v_rcp_f32 v19, v19
v_rcp_f32 v26, v26
v_rcp_f32 v27, v27
s_nop 0
v_pk_fma_f32 v[100:101], v[34:35], v[18:19], v[100:101]
v_pk_fma_f32 v[104:105], v[50:51], v[26:27], v[104:105]
SM1_A1:
s_cmp_eq_u32 s49, 2
s_cbranch_scc1 SM1_F2
v_pk_add_f32 v[20:21], v[20:21], 1.0 op_sel_hi:[1,0]
v_pk_add_f32 v[28:29], v[28:29], 1.0 op_sel_hi:[1,0]
v_rcp_f32 v20, v20
v_rcp_f32 v21, v21
v_rcp_f32 v28, v28
v_rcp_f32 v29, v29
s_nop 0
v_pk_fma_f32 v[100:101], v[36:37], v[20:21], v[100:101]
v_pk_fma_f32 v[104:105], v[52:53], v[28:29], v[104:105]
SM1_A2:
s_cmp_eq_u32 s49, 3
s_cbranch_scc1 SM1_F3
v_pk_add_f32 v[22:23], v[22:23], 1.0 op_sel_hi:[1,0]
v_pk_add_f32 v[30:31], v[30:31], 1.0 op_sel_hi:[1,0]
v_rcp_f32 v22, v22
v_rcp_f32 v23, v23
v_rcp_f32 v30, v30
v_rcp_f32 v31, v31
s_nop 0
v_pk_fma_f32 v[100:101], v[38:39], v[22:23], v[100:101]
v_pk_fma_f32 v[104:105], v[54:55], v[30:31], v[104:105]
s_branch SM1_J0
SM1_C1:
s_cmp_eq_u32 s49, 4
s_cbranch_scc1 SM1_F4
v_pk_add_f32 v[32:33], v[32:33], 1.0 op_sel_hi:[1,0]
v_pk_add_f32 v[48:49], v[48:49], 1.0 op_sel_hi:[1,0]
v_rcp_f32 v32, v32
v_rcp_f32 v33, v33
v_rcp_f32 v48, v48
v_rcp_f32 v49, v49
s_nop 0
v_pk_fma_f32 v[100:101], v[40:41], v[32:33], v[100:101]
v_pk_fma_f32 v[104:105], v[56:57], v[48:49], v[104:105]
SM1_A4:
s_cmp_eq_u32 s49, 5
s_cbranch_scc1 SM1_F5
v_pk_add_f32 v[34:35], v[34:35], 1.0 op_sel_hi:[1,0]
v_pk_add_f32 v[50:51], v[50:51], 1.0 op_sel_hi:[1,0]
v_rcp_f32 v34, v34
v_rcp_f32 v35, v35
v_rcp_f32 v50, v50
v_rcp_f32 v51, v51
s_nop 0
v_pk_fma_f32 v[100:101], v[42:43], v[34:35], v[100:101]
v_pk_fma_f32 v[104:105], v[58:59], v[50:51], v[104:105]
SM1_A5:
s_cmp_eq_u32 s49, 6
s_cbranch_scc1 SM1_F6
v_pk_add_f32 v[36:37], v[36:37], 1.0 op_sel_hi:[1,0]
v_pk_add_f32 v[52:53], v[52:53], 1.0 op_sel_hi:[1,0]
v_rcp_f32 v36, v36
v_rcp_f32 v37, v37
v_rcp_f32 v52, v52
v_rcp_f32 v53, v53
s_nop 0
v_pk_fma_f32 v[100:101], v[44:45], v[36:37], v[100:101]
v_pk_fma_f32 v[104:105], v[60:61], v[52:53], v[104:105]
SM1_A6:
s_cmp_eq_u32 s49, 7
s_cbranch_scc1 SM1_F7
v_pk_add_f32 v[38:39], v[38:39], 1.0 op_sel_hi:[1,0]
v_pk_add_f32 v[54:55], v[54:55], 1.0 op_sel_hi:[1,0]
v_rcp_f32 v38, v38
v_rcp_f32 v39, v39
v_rcp_f32 v54, v54
v_rcp_f32 v55, v55
s_nop 0
v_pk_fma_f32 v[100:101], v[46:47], v[38:39], v[100:101]
v_pk_fma_f32 v[104:105], v[62:63], v[54:55], v[104:105]
s_branch SM1_J1
SM1_F0:
s_add_u32 s51, s51, 1
v_readlane_b32 s52, v127, s51
v_add_f32 v112, v100, v101
v_add_f32 v113, v104, v105
v_cvt_f64_f32 v[110:111], v112
v_cvt_f64_f32 v[114:115], v113
ds_add_f64 v126, v[110:111]
ds_add_f64 v126, v[114:115] offset:256
v_add_u32 v126, 528, v126
s_sub_u32 s49, s52, s50
v_mov_b32 v100, 0
v_mov_b32 v101, 0
v_mov_b32 v104, 0
v_mov_b32 v105, 0
v_pk_add_f32 v[16:17], v[16:17], 1.0 op_sel_hi:[1,0]
v_pk_add_f32 v[24:25], v[24:25], 1.0 op_sel_hi:[1,0]
v_rcp_f32 v16, v16
v_rcp_f32 v17, v17
v_rcp_f32 v24, v24
v_rcp_f32 v25, v25
s_nop 0
v_pk_fma_f32 v[100:101], v[32:33], v[16:17], v[100:101]
v_pk_fma_f32 v[104:105], v[48:49], v[24:25], v[104:105]
s_branch SM1_A0
SM1_F1:
s_add_u32 s51, s51, 1
v_readlane_b32 s52, v127, s51
v_add_f32 v112, v100, v101
v_add_f32 v113, v104, v105
v_cvt_f64_f32 v[110:111], v112
v_cvt_f64_f32 v[114:115], v113
ds_add_f64 v126, v[110:111]
ds_add_f64 v126, v[114:115] offset:256
v_add_u32 v126, 528, v126
s_sub_u32 s49, s52, s50
v_mov_b32 v100, 0
v_mov_b32 v101, 0
v_mov_b32 v104, 0
v_mov_b32 v105, 0
v_pk_add_f32 v[18:19], v[18:19], 1.0 op_sel_hi:[1,0]
v_pk_add_f32 v[26:27], v[26:27], 1.0 op_sel_hi:[1,0]
v_rcp_f32 v18, v18
v_rcp_f32 v19, v19
v_rcp_f32 v26, v26
v_rcp_f32 v27, v27
s_nop 0
v_pk_fma_f32 v[100:101], v[34:35], v[18:19], v[100:101]
v_pk_fma_f32 v[104:105], v[50:51], v[26:27], v[104:105]
s_branch SM1_A1
SM1_F2:
s_add_u32 s51, s51, 1
v_readlane_b32 s52, v127, s51
v_add_f32 v112, v100, v101
v_add_f32 v113, v104, v105
v_cvt_f64_f32 v[110:111], v112
v_cvt_f64_f32 v[114:115], v113
ds_add_f64 v126, v[110:111]
ds_add_f64 v126, v[114:115] offset:256
v_add_u32 v126, 528, v126
s_sub_u32 s49, s52, s50
v_mov_b32 v100, 0
v_mov_b32 v101, 0
v_mov_b32 v104, 0
v_mov_b32 v105, 0
v_pk_add_f32 v[20:21], v[20:21], 1.0 op_sel_hi:[1,0]
v_pk_add_f32 v[28:29], v[28:29], 1.0 op_sel_hi:[1,0]
v_rcp_f32 v20, v20
v_rcp_f32 v21, v21
v_rcp_f32 v28, v28
v_rcp_f32 v29, v29
s_nop 0
v_pk_fma_f32 v[100:101], v[36:37], v[20:21], v[100:101]
v_pk_fma_f32 v[104:105], v[52:53], v[28:29], v[104:105]
s_branch SM1_A2
SM1_F3:
s_add_u32 s51, s51, 1
v_readlane_b32 s52, v127, s51
v_add_f32 v112, v100, v101
v_add_f32 v113, v104, v105
v_cvt_f64_f32 v[110:111], v112
v_cvt_f64_f32 v[114:115], v113
ds_add_f64 v126, v[110:111]
ds_add_f64 v126, v[114:115] offset:256
v_add_u32 v126, 528, v126
s_sub_u32 s49, s52, s50
v_mov_b32 v100, 0
v_mov_b32 v101, 0
v_mov_b32 v104, 0
v_mov_b32 v105, 0
v_pk_add_f32 v[22:23], v[22:23], 1.0 op_sel_hi:[1,0]
v_pk_add_f32 v[30:31], v[30:31], 1.0 op_sel_hi:[1,0]
v_rcp_f32 v22, v22
v_rcp_f32 v23, v23
v_rcp_f32 v30, v30
v_rcp_f32 v31, v31
s_nop 0
v_pk_fma_f32 v[100:101], v[38:39], v[22:23], v[100:101]
v_pk_fma_f32 v[104:105], v[54:55], v[30:31], v[104:105]
s_branch SM1_J0
SM1_F4:
s_add_u32 s51, s51, 1
v_readlane_b32 s52, v127, s51
v_add_f32 v112, v100, v101
v_add_f32 v113, v104, v105
v_cvt_f64_f32 v[110:111], v112
v_cvt_f64_f32 v[114:115], v113
ds_add_f64 v126, v[110:111]
ds_add_f64 v126, v[114:115] offset:256
v_add_u32 v126, 528, v126
s_sub_u32 s49, s52, s50
v_mov_b32 v100, 0
v_mov_b32 v101, 0
v_mov_b32 v104, 0
v_mov_b32 v105, 0
v_pk_add_f32 v[32:33], v[32:33], 1.0 op_sel_hi:[1,0]
v_pk_add_f32 v[48:49], v[48:49], 1.0 op_sel_hi:[1,0]
v_rcp_f32 v32, v32
v_rcp_f32 v33, v33
v_rcp_f32 v48, v48
v_rcp_f32 v49, v49
s_nop 0
v_pk_fma_f32 v[100:101], v[40:41], v[32:33], v[100:101]
v_pk_fma_f32 v[104:105], v[56:57], v[48:49], v[104:105]
s_branch SM1_A4
SM1_F5:
s_add_u32 s51, s51, 1
v_readlane_b32 s52, v127, s51
v_add_f32 v112, v100, v101
v_add_f32 v113, v104, v105
v_cvt_f64_f32 v[110:111], v112
v_cvt_f64_f32 v[114:115], v113
ds_add_f64 v126, v[110:111]
ds_add_f64 v126, v[114:115] offset:256
v_add_u32 v126, 528, v126
s_sub_u32 s49, s52, s50
v_mov_b32 v100, 0
v_mov_b32 v101, 0
v_mov_b32 v104, 0
v_mov_b32 v105, 0
v_pk_add_f32 v[34:35], v[34:35], 1.0 op_sel_hi:[1,0]
v_pk_add_f32 v[50:51], v[50:51], 1.0 op_sel_hi:[1,0]
v_rcp_f32 v34, v34
v_rcp_f32 v35, v35
v_rcp_f32 v50, v50
v_rcp_f32 v51, v51
s_nop 0
v_pk_fma_f32 v[100:101], v[42:43], v[34:35], v[100:101]
v_pk_fma_f32 v[104:105], v[58:59], v[50:51], v[104:105]
s_branch SM1_A5
SM1_F6:
s_add_u32 s51, s51, 1
v_readlane_b32 s52, v127, s51
v_add_f32 v112, v100, v101
v_add_f32 v113, v104, v105
v_cvt_f64_f32 v[110:111], v112
v_cvt_f64_f32 v[114:115], v113
ds_add_f64 v126, v[110:111]
ds_add_f64 v126, v[114:115] offset:256
v_add_u32 v126, 528, v126
s_sub_u32 s49, s52, s50
v_mov_b32 v100, 0
v_mov_b32 v101, 0
v_mov_b32 v104, 0
v_mov_b32 v105, 0
v_pk_add_f32 v[36:37], v[36:37], 1.0 op_sel_hi:[1,0]
v_pk_add_f32 v[52:53], v[52:53], 1.0 op_sel_hi:[1,0]
v_rcp_f32 v36, v36
v_rcp_f32 v37, v37
v_rcp_f32 v52, v52
v_rcp_f32 v53, v53
s_nop 0
v_pk_fma_f32 v[100:101], v[44:45], v[36:37], v[100:101]
v_pk_fma_f32 v[104:105], v[60:61], v[52:53], v[104:105]
s_branch SM1_A6
SM1_F7:
s_add_u32 s51, s51, 1
v_readlane_b32 s52, v127, s51
v_add_f32 v112, v100, v101
v_add_f32 v113, v104, v105
v_cvt_f64_f32 v[110:111], v112
v_cvt_f64_f32 v[114:115], v113
ds_add_f64 v126, v[110:111]
ds_add_f64 v126, v[114:115] offset:256
v_add_u32 v126, 528, v126
s_sub_u32 s49, s52, s50
v_mov_b32 v100, 0
v_mov_b32 v101, 0
v_mov_b32 v104, 0
v_mov_b32 v105, 0
v_pk_add_f32 v[38:39], v[38:39], 1.0 op_sel_hi:[1,0]
v_pk_add_f32 v[54:55], v[54:55], 1.0 op_sel_hi:[1,0]
v_rcp_f32 v38, v38
v_rcp_f32 v39, v39
v_rcp_f32 v54, v54
v_rcp_f32 v55, v55
s_nop 0
v_pk_fma_f32 v[100:101], v[46:47], v[38:39], v[100:101]
v_pk_fma_f32 v[104:105], v[62:63], v[54:55], v[104:105]
s_branch SM1_J1
SD0_C0:
s_cmp_eq_u32 s49, 0
s_cbranch_scc1 SD0_F0
v_pk_add_f32 v[48:49], v[48:49], 1.0 op_sel_hi:[1,0]
v_pk_add_f32 v[56:57], v[56:57], 1.0 op_sel_hi:[1,0]
v_rcp_f32 v48, v48
v_rcp_f32 v49, v49
v_rcp_f32 v56, v56
v_rcp_f32 v57, v57
s_nop 0
v_pk_fma_f32 v[100:101], v[0:1], v[48:49], v[100:101]
v_pk_fma_f32 v[104:105], v[16:17], v[56:57], v[104:105]
SD0_A0:
s_cmp_eq_u32 s49, 1
s_cbranch_scc1 SD0_F1
v_pk_add_f32 v[50:51], v[50:51], 1.0 op_sel_hi:[1,0]
v_pk_add_f32 v[58:59], v[58:59], 1.0 op_sel_hi:[1,0]
v_rcp_f32 v50, v50
v_rcp_f32 v51, v51
v_rcp_f32 v58, v58
v_rcp_f32 v59, v59
s_nop 0
v_pk_fma_f32 v[100:101], v[2:3], v[50:51], v[100:101]
v_pk_fma_f32 v[104:105], v[18:19], v[58:59], v[104:105]
SD0_A1:
s_cmp_eq_u32 s49, 2
s_cbranch_scc1 SD0_F2
v_pk_add_f32 v[52:53], v[52:53], 1.0 op_sel_hi:[1,0]
v_pk_add_f32 v[60:61], v[60:61], 1.0 op_sel_hi:[1,0]
v_rcp_f32 v52, v52
v_rcp_f32 v53, v53
v_rcp_f32 v60, v60
v_rcp_f32 v61, v61
s_nop 0
v_pk_fma_f32 v[100:101], v[4:5], v[52:53], v[100:101]
v_pk_fma_f32 v[104:105], v[20:21], v[60:61], v[104:105]
SD0_A2:
s_cmp_eq_u32 s49, 3
s_cbranch_scc1 SD0_F3
v_pk_add_f32 v[54:55], v[54:55], 1.0 op_sel_hi:[1,0]
v_pk_add_f32 v[62:63], v[62:63], 1.0 op_sel_hi:[1,0]
v_rcp_f32 v54, v54
v_rcp_f32 v55, v55
v_rcp_f32 v62, v62
v_rcp_f32 v63, v63
s_nop 0
v_pk_fma_f32 v[100:101], v[6:7], v[54:55], v[100:101]
v_pk_fma_f32 v[104:105], v[22:23], v[62:63], v[104:105]
s_branch SD0_J0
SD0_C1:
s_cmp_eq_u32 s49, 4
s_cbranch_scc1 SD0_F4
v_pk_add_f32 v[0:1], v[0:1], 1.0 op_sel_hi:[1,0]
v_pk_add_f32 v[16:17], v[16:17], 1.0 op_sel_hi:[1,0]
v_rcp_f32 v0, v0
v_rcp_f32 v1, v1
v_rcp_f32 v16, v16
v_rcp_f32 v17, v17
s_nop 0
v_pk_fma_f32 v[100:101], v[8:9], v[0:1], v[100:101]
v_pk_fma_f32 v[104:105], v[24:25], v[16:17], v[104:105]
SD0_A4:
s_cmp_eq_u32 s49, 5
s_cbranch_scc1 SD0_F5
v_pk_add_f32 v[2:3], v[2:3], 1.0 op_sel_hi:[1,0]
v_pk_add_f32 v[18:19], v[18:19], 1.0 op_sel_hi:[1,0]
v_rcp_f32 v2, v2
v_rcp_f32 v3, v3
v_rcp_f32 v18, v18
v_rcp_f32 v19, v19
s_nop 0
v_pk_fma_f32 v[100:101], v[10:11], v[2:3], v[100:101]
v_pk_fma_f32 v[104:105], v[26:27], v[18:19], v[104:105]
SD0_A5:
s_cmp_eq_u32 s49, 6
s_cbranch_scc1 SD0_F6
v_pk_add_f32 v[4:5], v[4:5], 1.0 op_sel_hi:[1,0]
v_pk_add_f32 v[20:21], v[20:21], 1.0 op_sel_hi:[1,0]
v_rcp_f32 v4, v4
v_rcp_f32 v5, v5
v_rcp_f32 v20, v20
v_rcp_f32 v21, v21
s_nop 0
v_pk_fma_f32 v[100:101], v[12:13], v[4:5], v[100:101]
v_pk_fma_f32 v[104:105], v[28:29], v[20:21], v[104:105]
SD0_A6:
s_cmp_eq_u32 s49, 7
s_cbranch_scc1 SD0_F7
v_pk_add_f32 v[6:7], v[6:7], 1.0 op_sel_hi:[1,0]
v_pk_add_f32 v[22:23], v[22:23], 1.0 op_sel_hi:[1,0]
v_rcp_f32 v6, v6
v_rcp_f32 v7, v7
v_rcp_f32 v22, v22
v_rcp_f32 v23, v23
s_nop 0
v_pk_fma_f32 v[100:101], v[14:15], v[6:7], v[100:101]
v_pk_fma_f32 v[104:105], v[30:31], v[22:23], v[104:105]
s_branch SD0_J1
SD0_F0:
s_add_u32 s51, s51, 1
v_readlane_b32 s52, v127, s51
v_add_f32 v112, v100, v101
v_add_f32 v113, v104, v105
v_cvt_f64_f32 v[110:111], v112
v_cvt_f64_f32 v[114:115], v113
ds_add_f64 v126, v[110:111]
ds_add_f64 v126, v[114:115] offset:256
v_add_u32 v126, 528, v126
s_sub_u32 s49, s52, s50
v_mov_b32 v100, 0
v_mov_b32 v101, 0
v_mov_b32 v104, 0
v_mov_b32 v105, 0
v_pk_add_f32 v[48:49], v[48:49], 1.0 op_sel_hi:[1,0]
v_pk_add_f32 v[56:57], v[56:57], 1.0 op_sel_hi:[1,0]
v_rcp_f32 v48, v48
v_rcp_f32 v49, v49
v_rcp_f32 v56, v56
v_rcp_f32 v57, v57
s_nop 0
v_pk_fma_f32 v[100:101], v[0:1], v[48:49], v[100:101]
v_pk_fma_f32 v[104:105], v[16:17], v[56:57], v[104:105]
s_branch SD0_A0
SD0_F1:
s_add_u32 s51, s51, 1
v_readlane_b32 s52, v127, s51
v_add_f32 v112, v100, v101
v_add_f32 v113, v104, v105
v_cvt_f64_f32 v[110:111], v112
v_cvt_f64_f32 v[114:115], v113
ds_add_f64 v126, v[110:111]
ds_add_f64 v126, v[114:115] offset:256
v_add_u32 v126, 528, v126
s_sub_u32 s49, s52, s50
v_mov_b32 v100, 0
v_mov_b32 v101, 0
v_mov_b32 v104, 0
v_mov_b32 v105, 0
v_pk_add_f32 v[50:51], v[50:51], 1.0 op_sel_hi:[1,0]
v_pk_add_f32 v[58:59], v[58:59], 1.0 op_sel_hi:[1,0]
v_rcp_f32 v50, v50
v_rcp_f32 v51, v51
v_rcp_f32 v58, v58
v_rcp_f32 v59, v59
s_nop 0
v_pk_fma_f32 v[100:101], v[2:3], v[50:51], v[100:101]
v_pk_fma_f32 v[104:105], v[18:19], v[58:59], v[104:105]
s_branch SD0_A1
SD0_F2:
s_add_u32 s51, s51, 1
v_readlane_b32 s52, v127, s51
v_add_f32 v112, v100, v101
v_add_f32 v113, v104, v105
v_cvt_f64_f32 v[110:111], v112
v_cvt_f64_f32 v[114:115], v113
ds_add_f64 v126, v[110:111]
ds_add_f64 v126, v[114:115] offset:256
v_add_u32 v126, 528, v126
s_sub_u32 s49, s52, s50
v_mov_b32 v100, 0
v_mov_b32 v101, 0
v_mov_b32 v104, 0
v_mov_b32 v105, 0
v_pk_add_f32 v[52:53], v[52:53], 1.0 op_sel_hi:[1,0]
v_pk_add_f32 v[60:61], v[60:61], 1.0 op_sel_hi:[1,0]
v_rcp_f32 v52, v52
v_rcp_f32 v53, v53
v_rcp_f32 v60, v60
v_rcp_f32 v61, v61
s_nop 0
v_pk_fma_f32 v[100:101], v[4:5], v[52:53], v[100:101]
v_pk_fma_f32 v[104:105], v[20:21], v[60:61], v[104:105]
s_branch SD0_A2
SD0_F3:
s_add_u32 s51, s51, 1
v_readlane_b32 s52, v127, s51
v_add_f32 v112, v100, v101
v_add_f32 v113, v104, v105
v_cvt_f64_f32 v[110:111], v112
v_cvt_f64_f32 v[114:115], v113
ds_add_f64 v126, v[110:111]
ds_add_f64 v126, v[114:115] offset:256
v_add_u32 v126, 528, v126
s_sub_u32 s49, s52, s50
v_mov_b32 v100, 0
v_mov_b32 v101, 0
v_mov_b32 v104, 0
v_mov_b32 v105, 0
v_pk_add_f32 v[54:55], v[54:55], 1.0 op_sel_hi:[1,0]
v_pk_add_f32 v[62:63], v[62:63], 1.0 op_sel_hi:[1,0]
v_rcp_f32 v54, v54
v_rcp_f32 v55, v55
v_rcp_f32 v62, v62
v_rcp_f32 v63, v63
s_nop 0
v_pk_fma_f32 v[100:101], v[6:7], v[54:55], v[100:101]
v_pk_fma_f32 v[104:105], v[22:23], v[62:63], v[104:105]
s_branch SD0_J0
SD0_F4:
s_add_u32 s51, s51, 1
v_readlane_b32 s52, v127, s51
v_add_f32 v112, v100, v101
v_add_f32 v113, v104, v105
v_cvt_f64_f32 v[110:111], v112
v_cvt_f64_f32 v[114:115], v113
ds_add_f64 v126, v[110:111]
ds_add_f64 v126, v[114:115] offset:256
v_add_u32 v126, 528, v126
s_sub_u32 s49, s52, s50
v_mov_b32 v100, 0
v_mov_b32 v101, 0
v_mov_b32 v104, 0
v_mov_b32 v105, 0
v_pk_add_f32 v[0:1], v[0:1], 1.0 op_sel_hi:[1,0]
v_pk_add_f32 v[16:17], v[16:17], 1.0 op_sel_hi:[1,0]
v_rcp_f32 v0, v0
v_rcp_f32 v1, v1
v_rcp_f32 v16, v16
v_rcp_f32 v17, v17
s_nop 0
v_pk_fma_f32 v[100:101], v[8:9], v[0:1], v[100:101]
v_pk_fma_f32 v[104:105], v[24:25], v[16:17], v[104:105]
s_branch SD0_A4
SD0_F5:
s_add_u32 s51, s51, 1
v_readlane_b32 s52, v127, s51
v_add_f32 v112, v100, v101
v_add_f32 v113, v104, v105
v_cvt_f64_f32 v[110:111], v112
v_cvt_f64_f32 v[114:115], v113
ds_add_f64 v126, v[110:111]
ds_add_f64 v126, v[114:115] offset:256
v_add_u32 v126, 528, v126
s_sub_u32 s49, s52, s50
v_mov_b32 v100, 0
v_mov_b32 v101, 0
v_mov_b32 v104, 0
v_mov_b32 v105, 0
v_pk_add_f32 v[2:3], v[2:3], 1.0 op_sel_hi:[1,0]
v_pk_add_f32 v[18:19], v[18:19], 1.0 op_sel_hi:[1,0]
v_rcp_f32 v2, v2
v_rcp_f32 v3, v3
v_rcp_f32 v18, v18
v_rcp_f32 v19, v19
s_nop 0
v_pk_fma_f32 v[100:101], v[10:11], v[2:3], v[100:101]
v_pk_fma_f32 v[104:105], v[26:27], v[18:19], v[104:105]
s_branch SD0_A5
SD0_F6:
s_add_u32 s51, s51, 1
v_readlane_b32 s52, v127, s51
v_add_f32 v112, v100, v101
v_add_f32 v113, v104, v105
v_cvt_f64_f32 v[110:111], v112
v_cvt_f64_f32 v[114:115], v113
ds_add_f64 v126, v[110:111]
ds_add_f64 v126, v[114:115] offset:256
v_add_u32 v126, 528, v126
s_sub_u32 s49, s52, s50
v_mov_b32 v100, 0
v_mov_b32 v101, 0
v_mov_b32 v104, 0
v_mov_b32 v105, 0
v_pk_add_f32 v[4:5], v[4:5], 1.0 op_sel_hi:[1,0]
v_pk_add_f32 v[20:21], v[20:21], 1.0 op_sel_hi:[1,0]
v_rcp_f32 v4, v4
v_rcp_f32 v5, v5
v_rcp_f32 v20, v20
v_rcp_f32 v21, v21
s_nop 0
v_pk_fma_f32 v[100:101], v[12:13], v[4:5], v[100:101]
v_pk_fma_f32 v[104:105], v[28:29], v[20:21], v[104:105]
s_branch SD0_A6
SD0_F7:
s_add_u32 s51, s51, 1
v_readlane_b32 s52, v127, s51
v_add_f32 v112, v100, v101
v_add_f32 v113, v104, v105
v_cvt_f64_f32 v[110:111], v112
v_cvt_f64_f32 v[114:115], v113
ds_add_f64 v126, v[110:111]
ds_add_f64 v126, v[114:115] offset:256
v_add_u32 v126, 528, v126
s_sub_u32 s49, s52, s50
v_mov_b32 v100, 0
v_mov_b32 v101, 0
v_mov_b32 v104, 0
v_mov_b32 v105, 0
v_pk_add_f32 v[6:7], v[6:7], 1.0 op_sel_hi:[1,0]
v_pk_add_f32 v[22:23], v[22:23], 1.0 op_sel_hi:[1,0]
v_rcp_f32 v6, v6
v_rcp_f32 v7, v7
v_rcp_f32 v22, v22
v_rcp_f32 v23, v23
s_nop 0
v_pk_fma_f32 v[100:101], v[14:15], v[6:7], v[100:101]
v_pk_fma_f32 v[104:105], v[30:31], v[22:23], v[104:105]
s_branch SD0_J1
SE1_C0:
s_cmp_eq_u32 s49, 0
s_cbranch_scc1 SE1_F0
v_pk_add_f32 v[16:17], v[16:17], 1.0 op_sel_hi:[1,0]
v_pk_add_f32 v[24:25], v[24:25], 1.0 op_sel_hi:[1,0]
v_rcp_f32 v16, v16
v_rcp_f32 v17, v17
v_rcp_f32 v24, v24
v_rcp_f32 v25, v25
s_nop 0
v_pk_fma_f32 v[100:101], v[32:33], v[16:17], v[100:101]
v_pk_fma_f32 v[104:105], v[48:49], v[24:25], v[104:105]
SE1_A0:
s_cmp_eq_u32 s49, 1
s_cbranch_scc1 SE1_F1
v_pk_add_f32 v[18:19], v[18:19], 1.0 op_sel_hi:[1,0]
v_pk_add_f32 v[26:27], v[26:27], 1.0 op_sel_hi:[1,0]
v_rcp_f32 v18, v18
v_rcp_f32 v19, v19
v_rcp_f32 v26, v26
v_rcp_f32 v27, v27
s_nop 0
v_pk_fma_f32 v[100:101], v[34:35], v[18:19], v[100:101]
v_pk_fma_f32 v[104:105], v[50:51], v[26:27], v[104:105]
SE1_A1:
s_cmp_eq_u32 s49, 2
s_cbranch_scc1 SE1_F2
v_pk_add_f32 v[20:21], v[20:21], 1.0 op_sel_hi:[1,0]
v_pk_add_f32 v[28:29], v[28:29], 1.0 op_sel_hi:[1,0]
v_rcp_f32 v20, v20
v_rcp_f32 v21, v21
v_rcp_f32 v28, v28
v_rcp_f32 v29, v29
s_nop 0
v_pk_fma_f32 v[100:101], v[36:37], v[20:21], v[100:101]
v_pk_fma_f32 v[104:105], v[52:53], v[28:29], v[104:105]
SE1_A2:
s_cmp_eq_u32 s49, 3
s_cbranch_scc1 SE1_F3
v_pk_add_f32 v[22:23], v[22:23], 1.0 op_sel_hi:[1,0]
v_pk_add_f32 v[30:31], v[30:31], 1.0 op_sel_hi:[1,0]
v_rcp_f32 v22, v22
v_rcp_f32 v23, v23
v_rcp_f32 v30, v30
v_rcp_f32 v31, v31
s_nop 0
v_pk_fma_f32 v[100:101], v[38:39], v[22:23], v[100:101]
v_pk_fma_f32 v[104:105], v[54:55], v[30:31], v[104:105]
s_branch SE1_J0
SE1_C1:
s_cmp_eq_u32 s49, 4
s_cbranch_scc1 SE1_F4
v_pk_add_f32 v[32:33], v[32:33], 1.0 op_sel_hi:[1,0]
v_pk_add_f32 v[48:49], v[48:49], 1.0 op_sel_hi:[1,0]
v_rcp_f32 v32, v32
v_rcp_f32 v33, v33
v_rcp_f32 v48, v48
v_rcp_f32 v49, v49
s_nop 0
v_pk_fma_f32 v[100:101], v[40:41], v[32:33], v[100:101]
v_pk_fma_f32 v[104:105], v[56:57], v[48:49], v[104:105]
SE1_A4:
s_cmp_eq_u32 s49, 5
s_cbranch_scc1 SE1_F5
v_pk_add_f32 v[34:35], v[34:35], 1.0 op_sel_hi:[1,0]
v_pk_add_f32 v[50:51], v[50:51], 1.0 op_sel_hi:[1,0]
v_rcp_f32 v34, v34
v_rcp_f32 v35, v35
v_rcp_f32 v50, v50
v_rcp_f32 v51, v51
s_nop 0
v_pk_fma_f32 v[100:101], v[42:43], v[34:35], v[100:101]
v_pk_fma_f32 v[104:105], v[58:59], v[50:51], v[104:105]
SE1_A5:
s_cmp_eq_u32 s49, 6
s_cbranch_scc1 SE1_F6
v_pk_add_f32 v[36:37], v[36:37], 1.0 op_sel_hi:[1,0]
v_pk_add_f32 v[52:53], v[52:53], 1.0 op_sel_hi:[1,0]
v_rcp_f32 v36, v36
v_rcp_f32 v37, v37
v_rcp_f32 v52, v52
v_rcp_f32 v53, v53
s_nop 0
v_pk_fma_f32 v[100:101], v[44:45], v[36:37], v[100:101]
v_pk_fma_f32 v[104:105], v[60:61], v[52:53], v[104:105]
SE1_A6:
s_cmp_eq_u32 s49, 7
s_cbranch_scc1 SE1_F7
v_pk_add_f32 v[38:39], v[38:39], 1.0 op_sel_hi:[1,0]
v_pk_add_f32 v[54:55], v[54:55], 1.0 op_sel_hi:[1,0]
v_rcp_f32 v38, v38
v_rcp_f32 v39, v39
v_rcp_f32 v54, v54
v_rcp_f32 v55, v55
s_nop 0
v_pk_fma_f32 v[100:101], v[46:47], v[38:39], v[100:101]
v_pk_fma_f32 v[104:105], v[62:63], v[54:55], v[104:105]
s_branch SE1_J1
SE1_F0:
s_add_u32 s51, s51, 1
v_readlane_b32 s52, v127, s51
v_add_f32 v112, v100, v101
v_add_f32 v113, v104, v105
v_cvt_f64_f32 v[110:111], v112
v_cvt_f64_f32 v[114:115], v113
ds_add_f64 v126, v[110:111]
ds_add_f64 v126, v[114:115] offset:256
v_add_u32 v126, 528, v126
s_sub_u32 s49, s52, s50
v_mov_b32 v100, 0
v_mov_b32 v101, 0
v_mov_b32 v104, 0
v_mov_b32 v105, 0
v_pk_add_f32 v[16:17], v[16:17], 1.0 op_sel_hi:[1,0]
v_pk_add_f32 v[24:25], v[24:25], 1.0 op_sel_hi:[1,0]
v_rcp_f32 v16, v16
v_rcp_f32 v17, v17
v_rcp_f32 v24, v24
v_rcp_f32 v25, v25
s_nop 0
v_pk_fma_f32 v[100:101], v[32:33], v[16:17], v[100:101]
v_pk_fma_f32 v[104:105], v[48:49], v[24:25], v[104:105]
s_branch SE1_A0
SE1_F1:
s_add_u32 s51, s51, 1
v_readlane_b32 s52, v127, s51
v_add_f32 v112, v100, v101
v_add_f32 v113, v104, v105
v_cvt_f64_f32 v[110:111], v112
v_cvt_f64_f32 v[114:115], v113
ds_add_f64 v126, v[110:111]
ds_add_f64 v126, v[114:115] offset:256
v_add_u32 v126, 528, v126
s_sub_u32 s49, s52, s50
v_mov_b32 v100, 0
v_mov_b32 v101, 0
v_mov_b32 v104, 0
v_mov_b32 v105, 0
v_pk_add_f32 v[18:19], v[18:19], 1.0 op_sel_hi:[1,0]
v_pk_add_f32 v[26:27], v[26:27], 1.0 op_sel_hi:[1,0]
v_rcp_f32 v18, v18
v_rcp_f32 v19, v19
v_rcp_f32 v26, v26
v_rcp_f32 v27, v27
s_nop 0
v_pk_fma_f32 v[100:101], v[34:35], v[18:19], v[100:101]
v_pk_fma_f32 v[104:105], v[50:51], v[26:27], v[104:105]
s_branch SE1_A1
SE1_F2:
s_add_u32 s51, s51, 1
v_readlane_b32 s52, v127, s51
v_add_f32 v112, v100, v101
v_add_f32 v113, v104, v105
v_cvt_f64_f32 v[110:111], v112
v_cvt_f64_f32 v[114:115], v113
ds_add_f64 v126, v[110:111]
ds_add_f64 v126, v[114:115] offset:256
v_add_u32 v126, 528, v126
s_sub_u32 s49, s52, s50
v_mov_b32 v100, 0
v_mov_b32 v101, 0
v_mov_b32 v104, 0
v_mov_b32 v105, 0
v_pk_add_f32 v[20:21], v[20:21], 1.0 op_sel_hi:[1,0]
v_pk_add_f32 v[28:29], v[28:29], 1.0 op_sel_hi:[1,0]
v_rcp_f32 v20, v20
v_rcp_f32 v21, v21
v_rcp_f32 v28, v28
v_rcp_f32 v29, v29
s_nop 0
v_pk_fma_f32 v[100:101], v[36:37], v[20:21], v[100:101]
v_pk_fma_f32 v[104:105], v[52:53], v[28:29], v[104:105]
s_branch SE1_A2
SE1_F3:
s_add_u32 s51, s51, 1
v_readlane_b32 s52, v127, s51
v_add_f32 v112, v100, v101
v_add_f32 v113, v104, v105
v_cvt_f64_f32 v[110:111], v112
v_cvt_f64_f32 v[114:115], v113
ds_add_f64 v126, v[110:111]
ds_add_f64 v126, v[114:115] offset:256
v_add_u32 v126, 528, v126
s_sub_u32 s49, s52, s50
v_mov_b32 v100, 0
v_mov_b32 v101, 0
v_mov_b32 v104, 0
v_mov_b32 v105, 0
v_pk_add_f32 v[22:23], v[22:23], 1.0 op_sel_hi:[1,0]
v_pk_add_f32 v[30:31], v[30:31], 1.0 op_sel_hi:[1,0]
v_rcp_f32 v22, v22
v_rcp_f32 v23, v23
v_rcp_f32 v30, v30
v_rcp_f32 v31, v31
s_nop 0
v_pk_fma_f32 v[100:101], v[38:39], v[22:23], v[100:101]
v_pk_fma_f32 v[104:105], v[54:55], v[30:31], v[104:105]
s_branch SE1_J0
SE1_F4:
s_add_u32 s51, s51, 1
v_readlane_b32 s52, v127, s51
v_add_f32 v112, v100, v101
v_add_f32 v113, v104, v105
v_cvt_f64_f32 v[110:111], v112
v_cvt_f64_f32 v[114:115], v113
ds_add_f64 v126, v[110:111]
ds_add_f64 v126, v[114:115] offset:256
v_add_u32 v126, 528, v126
s_sub_u32 s49, s52, s50
v_mov_b32 v100, 0
v_mov_b32 v101, 0
v_mov_b32 v104, 0
v_mov_b32 v105, 0
v_pk_add_f32 v[32:33], v[32:33], 1.0 op_sel_hi:[1,0]
v_pk_add_f32 v[48:49], v[48:49], 1.0 op_sel_hi:[1,0]
v_rcp_f32 v32, v32
v_rcp_f32 v33, v33
v_rcp_f32 v48, v48
v_rcp_f32 v49, v49
s_nop 0
v_pk_fma_f32 v[100:101], v[40:41], v[32:33], v[100:101]
v_pk_fma_f32 v[104:105], v[56:57], v[48:49], v[104:105]
s_branch SE1_A4
SE1_F5:
s_add_u32 s51, s51, 1
v_readlane_b32 s52, v127, s51
v_add_f32 v112, v100, v101
v_add_f32 v113, v104, v105
v_cvt_f64_f32 v[110:111], v112
v_cvt_f64_f32 v[114:115], v113
ds_add_f64 v126, v[110:111]
ds_add_f64 v126, v[114:115] offset:256
v_add_u32 v126, 528, v126
s_sub_u32 s49, s52, s50
v_mov_b32 v100, 0
v_mov_b32 v101, 0
v_mov_b32 v104, 0
v_mov_b32 v105, 0
v_pk_add_f32 v[34:35], v[34:35], 1.0 op_sel_hi:[1,0]
v_pk_add_f32 v[50:51], v[50:51], 1.0 op_sel_hi:[1,0]
v_rcp_f32 v34, v34
v_rcp_f32 v35, v35
v_rcp_f32 v50, v50
v_rcp_f32 v51, v51
s_nop 0
v_pk_fma_f32 v[100:101], v[42:43], v[34:35], v[100:101]
v_pk_fma_f32 v[104:105], v[58:59], v[50:51], v[104:105]
s_branch SE1_A5
SE1_F6:
s_add_u32 s51, s51, 1
v_readlane_b32 s52, v127, s51
v_add_f32 v112, v100, v101
v_add_f32 v113, v104, v105
v_cvt_f64_f32 v[110:111], v112
v_cvt_f64_f32 v[114:115], v113
ds_add_f64 v126, v[110:111]
ds_add_f64 v126, v[114:115] offset:256
v_add_u32 v126, 528, v126
s_sub_u32 s49, s52, s50
v_mov_b32 v100, 0
v_mov_b32 v101, 0
v_mov_b32 v104, 0
v_mov_b32 v105, 0
v_pk_add_f32 v[36:37], v[36:37], 1.0 op_sel_hi:[1,0]
v_pk_add_f32 v[52:53], v[52:53], 1.0 op_sel_hi:[1,0]
v_rcp_f32 v36, v36
v_rcp_f32 v37, v37
v_rcp_f32 v52, v52
v_rcp_f32 v53, v53
s_nop 0
v_pk_fma_f32 v[100:101], v[44:45], v[36:37], v[100:101]
v_pk_fma_f32 v[104:105], v[60:61], v[52:53], v[104:105]
s_branch SE1_A6
SE1_F7:
s_add_u32 s51, s51, 1
v_readlane_b32 s52, v127, s51
v_add_f32 v112, v100, v101
v_add_f32 v113, v104, v105
v_cvt_f64_f32 v[110:111], v112
v_cvt_f64_f32 v[114:115], v113
ds_add_f64 v126, v[110:111]
ds_add_f64 v126, v[114:115] offset:256
v_add_u32 v126, 528, v126
s_sub_u32 s49, s52, s50
v_mov_b32 v100, 0
v_mov_b32 v101, 0
v_mov_b32 v104, 0
v_mov_b32 v105, 0
v_pk_add_f32 v[38:39], v[38:39], 1.0 op_sel_hi:[1,0]
v_pk_add_f32 v[54:55], v[54:55], 1.0 op_sel_hi:[1,0]
v_rcp_f32 v38, v38
v_rcp_f32 v39, v39
v_rcp_f32 v54, v54
v_rcp_f32 v55, v55
s_nop 0
v_pk_fma_f32 v[100:101], v[46:47], v[38:39], v[100:101]
v_pk_fma_f32 v[104:105], v[62:63], v[54:55], v[104:105]
s_branch SE1_J1
SL0_C0:
s_cmp_eq_u32 s49, 0
s_cbranch_scc1 SL0_F0
v_pk_add_f32 v[48:49], v[48:49], 1.0 op_sel_hi:[1,0]
v_pk_add_f32 v[56:57], v[56:57], 1.0 op_sel_hi:[1,0]
v_rcp_f32 v48, v48
v_rcp_f32 v49, v49
v_rcp_f32 v56, v56
v_rcp_f32 v57, v57
s_nop 0
v_pk_fma_f32 v[100:101], v[0:1], v[48:49], v[100:101]
v_pk_fma_f32 v[104:105], v[16:17], v[56:57], v[104:105]
SL0_A0:
s_cmp_eq_u32 s49, 1
s_cbranch_scc1 SL0_F1
v_pk_add_f32 v[50:51], v[50:51], 1.0 op_sel_hi:[1,0]
v_pk_add_f32 v[58:59], v[58:59], 1.0 op_sel_hi:[1,0]
v_rcp_f32 v50, v50
v_rcp_f32 v51, v51
v_rcp_f32 v58, v58
v_rcp_f32 v59, v59
s_nop 0
v_pk_fma_f32 v[100:101], v[2:3], v[50:51], v[100:101]
v_pk_fma_f32 v[104:105], v[18:19], v[58:59], v[104:105]
SL0_A1:
s_cmp_eq_u32 s49, 2
s_cbranch_scc1 SL0_F2
v_pk_add_f32 v[52:53], v[52:53], 1.0 op_sel_hi:[1,0]
v_pk_add_f32 v[60:61], v[60:61], 1.0 op_sel_hi:[1,0]
v_rcp_f32 v52, v52
v_rcp_f32 v53, v53
v_rcp_f32 v60, v60
v_rcp_f32 v61, v61
s_nop 0
v_pk_fma_f32 v[100:101], v[4:5], v[52:53], v[100:101]
v_pk_fma_f32 v[104:105], v[20:21], v[60:61], v[104:105]
SL0_A2:
s_cmp_eq_u32 s49, 3
s_cbranch_scc1 SL0_F3
v_pk_add_f32 v[54:55], v[54:55], 1.0 op_sel_hi:[1,0]
v_pk_add_f32 v[62:63], v[62:63], 1.0 op_sel_hi:[1,0]
v_rcp_f32 v54, v54
v_rcp_f32 v55, v55
v_rcp_f32 v62, v62
v_rcp_f32 v63, v63
s_nop 0
v_pk_fma_f32 v[100:101], v[6:7], v[54:55], v[100:101]
v_pk_fma_f32 v[104:105], v[22:23], v[62:63], v[104:105]
s_branch SL0_J0
SL0_C1:
s_cmp_eq_u32 s49, 4
s_cbranch_scc1 SL0_F4
v_pk_add_f32 v[0:1], v[0:1], 1.0 op_sel_hi:[1,0]
v_pk_add_f32 v[16:17], v[16:17], 1.0 op_sel_hi:[1,0]
v_rcp_f32 v0, v0
v_rcp_f32 v1, v1
v_rcp_f32 v16, v16
v_rcp_f32 v17, v17
s_nop 0
v_pk_fma_f32 v[100:101], v[8:9], v[0:1], v[100:101]
v_pk_fma_f32 v[104:105], v[24:25], v[16:17], v[104:105]
SL0_A4:
s_cmp_eq_u32 s49, 5
s_cbranch_scc1 SL0_F5
v_pk_add_f32 v[2:3], v[2:3], 1.0 op_sel_hi:[1,0]
v_pk_add_f32 v[18:19], v[18:19], 1.0 op_sel_hi:[1,0]
v_rcp_f32 v2, v2
v_rcp_f32 v3, v3
v_rcp_f32 v18, v18
v_rcp_f32 v19, v19
s_nop 0
v_pk_fma_f32 v[100:101], v[10:11], v[2:3], v[100:101]
v_pk_fma_f32 v[104:105], v[26:27], v[18:19], v[104:105]
SL0_A5:
s_cmp_eq_u32 s49, 6
s_cbranch_scc1 SL0_F6
v_pk_add_f32 v[4:5], v[4:5], 1.0 op_sel_hi:[1,0]
v_pk_add_f32 v[20:21], v[20:21], 1.0 op_sel_hi:[1,0]
v_rcp_f32 v4, v4
v_rcp_f32 v5, v5
v_rcp_f32 v20, v20
v_rcp_f32 v21, v21
s_nop 0
v_pk_fma_f32 v[100:101], v[12:13], v[4:5], v[100:101]
v_pk_fma_f32 v[104:105], v[28:29], v[20:21], v[104:105]
SL0_A6:
s_cmp_eq_u32 s49, 7
s_cbranch_scc1 SL0_F7
v_pk_add_f32 v[6:7], v[6:7], 1.0 op_sel_hi:[1,0]
v_pk_add_f32 v[22:23], v[22:23], 1.0 op_sel_hi:[1,0]
v_rcp_f32 v6, v6
v_rcp_f32 v7, v7
v_rcp_f32 v22, v22
v_rcp_f32 v23, v23
s_nop 0
v_pk_fma_f32 v[100:101], v[14:15], v[6:7], v[100:101]
v_pk_fma_f32 v[104:105], v[30:31], v[22:23], v[104:105]
s_branch SL0_J1
SL0_F0:
s_add_u32 s51, s51, 1
v_readlane_b32 s52, v127, s51
v_add_f32 v112, v100, v101
v_add_f32 v113, v104, v105
v_cvt_f64_f32 v[110:111], v112
v_cvt_f64_f32 v[114:115], v113
ds_add_f64 v126, v[110:111]
ds_add_f64 v126, v[114:115] offset:256
v_add_u32 v126, 528, v126
s_sub_u32 s49, s52, s50
v_mov_b32 v100, 0
v_mov_b32 v101, 0
v_mov_b32 v104, 0
v_mov_b32 v105, 0
v_pk_add_f32 v[48:49], v[48:49], 1.0 op_sel_hi:[1,0]
v_pk_add_f32 v[56:57], v[56:57], 1.0 op_sel_hi:[1,0]
v_rcp_f32 v48, v48
v_rcp_f32 v49, v49
v_rcp_f32 v56, v56
v_rcp_f32 v57, v57
s_nop 0
v_pk_fma_f32 v[100:101], v[0:1], v[48:49], v[100:101]
v_pk_fma_f32 v[104:105], v[16:17], v[56:57], v[104:105]
s_branch SL0_A0
SL0_F1:
s_add_u32 s51, s51, 1
v_readlane_b32 s52, v127, s51
v_add_f32 v112, v100, v101
v_add_f32 v113, v104, v105
v_cvt_f64_f32 v[110:111], v112
v_cvt_f64_f32 v[114:115], v113
ds_add_f64 v126, v[110:111]
ds_add_f64 v126, v[114:115] offset:256
v_add_u32 v126, 528, v126
s_sub_u32 s49, s52, s50
v_mov_b32 v100, 0
v_mov_b32 v101, 0
v_mov_b32 v104, 0
v_mov_b32 v105, 0
v_pk_add_f32 v[50:51], v[50:51], 1.0 op_sel_hi:[1,0]
v_pk_add_f32 v[58:59], v[58:59], 1.0 op_sel_hi:[1,0]
v_rcp_f32 v50, v50
v_rcp_f32 v51, v51
v_rcp_f32 v58, v58
v_rcp_f32 v59, v59
s_nop 0
v_pk_fma_f32 v[100:101], v[2:3], v[50:51], v[100:101]
v_pk_fma_f32 v[104:105], v[18:19], v[58:59], v[104:105]
s_branch SL0_A1
SL0_F2:
s_add_u32 s51, s51, 1
v_readlane_b32 s52, v127, s51
v_add_f32 v112, v100, v101
v_add_f32 v113, v104, v105
v_cvt_f64_f32 v[110:111], v112
v_cvt_f64_f32 v[114:115], v113
ds_add_f64 v126, v[110:111]
ds_add_f64 v126, v[114:115] offset:256
v_add_u32 v126, 528, v126
s_sub_u32 s49, s52, s50
v_mov_b32 v100, 0
v_mov_b32 v101, 0
v_mov_b32 v104, 0
v_mov_b32 v105, 0
v_pk_add_f32 v[52:53], v[52:53], 1.0 op_sel_hi:[1,0]
v_pk_add_f32 v[60:61], v[60:61], 1.0 op_sel_hi:[1,0]
v_rcp_f32 v52, v52
v_rcp_f32 v53, v53
v_rcp_f32 v60, v60
v_rcp_f32 v61, v61
s_nop 0
v_pk_fma_f32 v[100:101], v[4:5], v[52:53], v[100:101]
v_pk_fma_f32 v[104:105], v[20:21], v[60:61], v[104:105]
s_branch SL0_A2
SL0_F3:
s_add_u32 s51, s51, 1
v_readlane_b32 s52, v127, s51
v_add_f32 v112, v100, v101
v_add_f32 v113, v104, v105
v_cvt_f64_f32 v[110:111], v112
v_cvt_f64_f32 v[114:115], v113
ds_add_f64 v126, v[110:111]
ds_add_f64 v126, v[114:115] offset:256
v_add_u32 v126, 528, v126
s_sub_u32 s49, s52, s50
v_mov_b32 v100, 0
v_mov_b32 v101, 0
v_mov_b32 v104, 0
v_mov_b32 v105, 0
v_pk_add_f32 v[54:55], v[54:55], 1.0 op_sel_hi:[1,0]
v_pk_add_f32 v[62:63], v[62:63], 1.0 op_sel_hi:[1,0]
v_rcp_f32 v54, v54
v_rcp_f32 v55, v55
v_rcp_f32 v62, v62
v_rcp_f32 v63, v63
s_nop 0
v_pk_fma_f32 v[100:101], v[6:7], v[54:55], v[100:101]
v_pk_fma_f32 v[104:105], v[22:23], v[62:63], v[104:105]
s_branch SL0_J0
SL0_F4:
s_add_u32 s51, s51, 1
v_readlane_b32 s52, v127, s51
v_add_f32 v112, v100, v101
v_add_f32 v113, v104, v105
v_cvt_f64_f32 v[110:111], v112
v_cvt_f64_f32 v[114:115], v113
ds_add_f64 v126, v[110:111]
ds_add_f64 v126, v[114:115] offset:256
v_add_u32 v126, 528, v126
s_sub_u32 s49, s52, s50
v_mov_b32 v100, 0
v_mov_b32 v101, 0
v_mov_b32 v104, 0
v_mov_b32 v105, 0
v_pk_add_f32 v[0:1], v[0:1], 1.0 op_sel_hi:[1,0]
v_pk_add_f32 v[16:17], v[16:17], 1.0 op_sel_hi:[1,0]
v_rcp_f32 v0, v0
v_rcp_f32 v1, v1
v_rcp_f32 v16, v16
v_rcp_f32 v17, v17
s_nop 0
v_pk_fma_f32 v[100:101], v[8:9], v[0:1], v[100:101]
v_pk_fma_f32 v[104:105], v[24:25], v[16:17], v[104:105]
s_branch SL0_A4
SL0_F5:
s_add_u32 s51, s51, 1
v_readlane_b32 s52, v127, s51
v_add_f32 v112, v100, v101
v_add_f32 v113, v104, v105
v_cvt_f64_f32 v[110:111], v112
v_cvt_f64_f32 v[114:115], v113
ds_add_f64 v126, v[110:111]
ds_add_f64 v126, v[114:115] offset:256
v_add_u32 v126, 528, v126
s_sub_u32 s49, s52, s50
v_mov_b32 v100, 0
v_mov_b32 v101, 0
v_mov_b32 v104, 0
v_mov_b32 v105, 0
v_pk_add_f32 v[2:3], v[2:3], 1.0 op_sel_hi:[1,0]
v_pk_add_f32 v[18:19], v[18:19], 1.0 op_sel_hi:[1,0]
v_rcp_f32 v2, v2
v_rcp_f32 v3, v3
v_rcp_f32 v18, v18
v_rcp_f32 v19, v19
s_nop 0
v_pk_fma_f32 v[100:101], v[10:11], v[2:3], v[100:101]
v_pk_fma_f32 v[104:105], v[26:27], v[18:19], v[104:105]
s_branch SL0_A5
SL0_F6:
s_add_u32 s51, s51, 1
v_readlane_b32 s52, v127, s51
v_add_f32 v112, v100, v101
v_add_f32 v113, v104, v105
v_cvt_f64_f32 v[110:111], v112
v_cvt_f64_f32 v[114:115], v113
ds_add_f64 v126, v[110:111]
ds_add_f64 v126, v[114:115] offset:256
v_add_u32 v126, 528, v126
s_sub_u32 s49, s52, s50
v_mov_b32 v100, 0
v_mov_b32 v101, 0
v_mov_b32 v104, 0
v_mov_b32 v105, 0
v_pk_add_f32 v[4:5], v[4:5], 1.0 op_sel_hi:[1,0]
v_pk_add_f32 v[20:21], v[20:21], 1.0 op_sel_hi:[1,0]
v_rcp_f32 v4, v4
v_rcp_f32 v5, v5
v_rcp_f32 v20, v20
v_rcp_f32 v21, v21
s_nop 0
v_pk_fma_f32 v[100:101], v[12:13], v[4:5], v[100:101]
v_pk_fma_f32 v[104:105], v[28:29], v[20:21], v[104:105]
s_branch SL0_A6
SL0_F7:
s_add_u32 s51, s51, 1
v_readlane_b32 s52, v127, s51
v_add_f32 v112, v100, v101
v_add_f32 v113, v104, v105
v_cvt_f64_f32 v[110:111], v112
v_cvt_f64_f32 v[114:115], v113
ds_add_f64 v126, v[110:111]
ds_add_f64 v126, v[114:115] offset:256
v_add_u32 v126, 528, v126
s_sub_u32 s49, s52, s50
v_mov_b32 v100, 0
v_mov_b32 v101, 0
v_mov_b32 v104, 0
v_mov_b32 v105, 0
v_pk_add_f32 v[6:7], v[6:7], 1.0 op_sel_hi:[1,0]
v_pk_add_f32 v[22:23], v[22:23], 1.0 op_sel_hi:[1,0]
v_rcp_f32 v6, v6
v_rcp_f32 v7, v7
v_rcp_f32 v22, v22
v_rcp_f32 v23, v23
s_nop 0
v_pk_fma_f32 v[100:101], v[14:15], v[6:7], v[100:101]
v_pk_fma_f32 v[104:105], v[30:31], v[22:23], v[104:105]
s_branch SL0_J1
SL1_C0:
s_cmp_eq_u32 s49, 0
s_cbranch_scc1 SL1_F0
v_pk_add_f32 v[16:17], v[16:17], 1.0 op_sel_hi:[1,0]
v_pk_add_f32 v[24:25], v[24:25], 1.0 op_sel_hi:[1,0]
v_rcp_f32 v16, v16
v_rcp_f32 v17, v17
v_rcp_f32 v24, v24
v_rcp_f32 v25, v25
s_nop 0
v_pk_fma_f32 v[100:101], v[32:33], v[16:17], v[100:101]
v_pk_fma_f32 v[104:105], v[48:49], v[24:25], v[104:105]
SL1_A0:
s_cmp_eq_u32 s49, 1
s_cbranch_scc1 SL1_F1
v_pk_add_f32 v[18:19], v[18:19], 1.0 op_sel_hi:[1,0]
v_pk_add_f32 v[26:27], v[26:27], 1.0 op_sel_hi:[1,0]
v_rcp_f32 v18, v18
v_rcp_f32 v19, v19
v_rcp_f32 v26, v26
v_rcp_f32 v27, v27
s_nop 0
v_pk_fma_f32 v[100:101], v[34:35], v[18:19], v[100:101]
v_pk_fma_f32 v[104:105], v[50:51], v[26:27], v[104:105]
SL1_A1:
s_cmp_eq_u32 s49, 2
s_cbranch_scc1 SL1_F2
v_pk_add_f32 v[20:21], v[20:21], 1.0 op_sel_hi:[1,0]
v_pk_add_f32 v[28:29], v[28:29], 1.0 op_sel_hi:[1,0]
v_rcp_f32 v20, v20
v_rcp_f32 v21, v21
v_rcp_f32 v28, v28
v_rcp_f32 v29, v29
s_nop 0
v_pk_fma_f32 v[100:101], v[36:37], v[20:21], v[100:101]
v_pk_fma_f32 v[104:105], v[52:53], v[28:29], v[104:105]
SL1_A2:
s_cmp_eq_u32 s49, 3
s_cbranch_scc1 SL1_F3
v_pk_add_f32 v[22:23], v[22:23], 1.0 op_sel_hi:[1,0]
v_pk_add_f32 v[30:31], v[30:31], 1.0 op_sel_hi:[1,0]
v_rcp_f32 v22, v22
v_rcp_f32 v23, v23
v_rcp_f32 v30, v30
v_rcp_f32 v31, v31
s_nop 0
v_pk_fma_f32 v[100:101], v[38:39], v[22:23], v[100:101]
v_pk_fma_f32 v[104:105], v[54:55], v[30:31], v[104:105]
s_branch SL1_J0
SL1_C1:
s_cmp_eq_u32 s49, 4
s_cbranch_scc1 SL1_F4
v_pk_add_f32 v[32:33], v[32:33], 1.0 op_sel_hi:[1,0]
v_pk_add_f32 v[48:49], v[48:49], 1.0 op_sel_hi:[1,0]
v_rcp_f32 v32, v32
v_rcp_f32 v33, v33
v_rcp_f32 v48, v48
v_rcp_f32 v49, v49
s_nop 0
v_pk_fma_f32 v[100:101], v[40:41], v[32:33], v[100:101]
v_pk_fma_f32 v[104:105], v[56:57], v[48:49], v[104:105]
SL1_A4:
s_cmp_eq_u32 s49, 5
s_cbranch_scc1 SL1_F5
v_pk_add_f32 v[34:35], v[34:35], 1.0 op_sel_hi:[1,0]
v_pk_add_f32 v[50:51], v[50:51], 1.0 op_sel_hi:[1,0]
v_rcp_f32 v34, v34
v_rcp_f32 v35, v35
v_rcp_f32 v50, v50
v_rcp_f32 v51, v51
s_nop 0
v_pk_fma_f32 v[100:101], v[42:43], v[34:35], v[100:101]
v_pk_fma_f32 v[104:105], v[58:59], v[50:51], v[104:105]
SL1_A5:
s_cmp_eq_u32 s49, 6
s_cbranch_scc1 SL1_F6
v_pk_add_f32 v[36:37], v[36:37], 1.0 op_sel_hi:[1,0]
v_pk_add_f32 v[52:53], v[52:53], 1.0 op_sel_hi:[1,0]
v_rcp_f32 v36, v36
v_rcp_f32 v37, v37
v_rcp_f32 v52, v52
v_rcp_f32 v53, v53
s_nop 0
v_pk_fma_f32 v[100:101], v[44:45], v[36:37], v[100:101]
v_pk_fma_f32 v[104:105], v[60:61], v[52:53], v[104:105]
SL1_A6:
s_cmp_eq_u32 s49, 7
s_cbranch_scc1 SL1_F7
v_pk_add_f32 v[38:39], v[38:39], 1.0 op_sel_hi:[1,0]
v_pk_add_f32 v[54:55], v[54:55], 1.0 op_sel_hi:[1,0]
v_rcp_f32 v38, v38
v_rcp_f32 v39, v39
v_rcp_f32 v54, v54
v_rcp_f32 v55, v55
s_nop 0
v_pk_fma_f32 v[100:101], v[46:47], v[38:39], v[100:101]
v_pk_fma_f32 v[104:105], v[62:63], v[54:55], v[104:105]
s_branch SL1_J1
SL1_F0:
s_add_u32 s51, s51, 1
v_readlane_b32 s52, v127, s51
v_add_f32 v112, v100, v101
v_add_f32 v113, v104, v105
v_cvt_f64_f32 v[110:111], v112
v_cvt_f64_f32 v[114:115], v113
ds_add_f64 v126, v[110:111]
ds_add_f64 v126, v[114:115] offset:256
v_add_u32 v126, 528, v126
s_sub_u32 s49, s52, s50
v_mov_b32 v100, 0
v_mov_b32 v101, 0
v_mov_b32 v104, 0
v_mov_b32 v105, 0
v_pk_add_f32 v[16:17], v[16:17], 1.0 op_sel_hi:[1,0]
v_pk_add_f32 v[24:25], v[24:25], 1.0 op_sel_hi:[1,0]
v_rcp_f32 v16, v16
v_rcp_f32 v17, v17
v_rcp_f32 v24, v24
v_rcp_f32 v25, v25
s_nop 0
v_pk_fma_f32 v[100:101], v[32:33], v[16:17], v[100:101]
v_pk_fma_f32 v[104:105], v[48:49], v[24:25], v[104:105]
s_branch SL1_A0
SL1_F1:
s_add_u32 s51, s51, 1
v_readlane_b32 s52, v127, s51
v_add_f32 v112, v100, v101
v_add_f32 v113, v104, v105
v_cvt_f64_f32 v[110:111], v112
v_cvt_f64_f32 v[114:115], v113
ds_add_f64 v126, v[110:111]
ds_add_f64 v126, v[114:115] offset:256
v_add_u32 v126, 528, v126
s_sub_u32 s49, s52, s50
v_mov_b32 v100, 0
v_mov_b32 v101, 0
v_mov_b32 v104, 0
v_mov_b32 v105, 0
v_pk_add_f32 v[18:19], v[18:19], 1.0 op_sel_hi:[1,0]
v_pk_add_f32 v[26:27], v[26:27], 1.0 op_sel_hi:[1,0]
v_rcp_f32 v18, v18
v_rcp_f32 v19, v19
v_rcp_f32 v26, v26
v_rcp_f32 v27, v27
s_nop 0
v_pk_fma_f32 v[100:101], v[34:35], v[18:19], v[100:101]
v_pk_fma_f32 v[104:105], v[50:51], v[26:27], v[104:105]
s_branch SL1_A1
SL1_F2:
s_add_u32 s51, s51, 1
v_readlane_b32 s52, v127, s51
v_add_f32 v112, v100, v101
v_add_f32 v113, v104, v105
v_cvt_f64_f32 v[110:111], v112
v_cvt_f64_f32 v[114:115], v113
ds_add_f64 v126, v[110:111]
ds_add_f64 v126, v[114:115] offset:256
v_add_u32 v126, 528, v126
s_sub_u32 s49, s52, s50
v_mov_b32 v100, 0
v_mov_b32 v101, 0
v_mov_b32 v104, 0
v_mov_b32 v105, 0
v_pk_add_f32 v[20:21], v[20:21], 1.0 op_sel_hi:[1,0]
v_pk_add_f32 v[28:29], v[28:29], 1.0 op_sel_hi:[1,0]
v_rcp_f32 v20, v20
v_rcp_f32 v21, v21
v_rcp_f32 v28, v28
v_rcp_f32 v29, v29
s_nop 0
v_pk_fma_f32 v[100:101], v[36:37], v[20:21], v[100:101]
v_pk_fma_f32 v[104:105], v[52:53], v[28:29], v[104:105]
s_branch SL1_A2
SL1_F3:
s_add_u32 s51, s51, 1
v_readlane_b32 s52, v127, s51
v_add_f32 v112, v100, v101
v_add_f32 v113, v104, v105
v_cvt_f64_f32 v[110:111], v112
v_cvt_f64_f32 v[114:115], v113
ds_add_f64 v126, v[110:111]
ds_add_f64 v126, v[114:115] offset:256
v_add_u32 v126, 528, v126
s_sub_u32 s49, s52, s50
v_mov_b32 v100, 0
v_mov_b32 v101, 0
v_mov_b32 v104, 0
v_mov_b32 v105, 0
v_pk_add_f32 v[22:23], v[22:23], 1.0 op_sel_hi:[1,0]
v_pk_add_f32 v[30:31], v[30:31], 1.0 op_sel_hi:[1,0]
v_rcp_f32 v22, v22
v_rcp_f32 v23, v23
v_rcp_f32 v30, v30
v_rcp_f32 v31, v31
s_nop 0
v_pk_fma_f32 v[100:101], v[38:39], v[22:23], v[100:101]
v_pk_fma_f32 v[104:105], v[54:55], v[30:31], v[104:105]
s_branch SL1_J0
SL1_F4:
s_add_u32 s51, s51, 1
v_readlane_b32 s52, v127, s51
v_add_f32 v112, v100, v101
v_add_f32 v113, v104, v105
v_cvt_f64_f32 v[110:111], v112
v_cvt_f64_f32 v[114:115], v113
ds_add_f64 v126, v[110:111]
ds_add_f64 v126, v[114:115] offset:256
v_add_u32 v126, 528, v126
s_sub_u32 s49, s52, s50
v_mov_b32 v100, 0
v_mov_b32 v101, 0
v_mov_b32 v104, 0
v_mov_b32 v105, 0
v_pk_add_f32 v[32:33], v[32:33], 1.0 op_sel_hi:[1,0]
v_pk_add_f32 v[48:49], v[48:49], 1.0 op_sel_hi:[1,0]
v_rcp_f32 v32, v32
v_rcp_f32 v33, v33
v_rcp_f32 v48, v48
v_rcp_f32 v49, v49
s_nop 0
v_pk_fma_f32 v[100:101], v[40:41], v[32:33], v[100:101]
v_pk_fma_f32 v[104:105], v[56:57], v[48:49], v[104:105]
s_branch SL1_A4
SL1_F5:
s_add_u32 s51, s51, 1
v_readlane_b32 s52, v127, s51
v_add_f32 v112, v100, v101
v_add_f32 v113, v104, v105
v_cvt_f64_f32 v[110:111], v112
v_cvt_f64_f32 v[114:115], v113
ds_add_f64 v126, v[110:111]
ds_add_f64 v126, v[114:115] offset:256
v_add_u32 v126, 528, v126
s_sub_u32 s49, s52, s50
v_mov_b32 v100, 0
v_mov_b32 v101, 0
v_mov_b32 v104, 0
v_mov_b32 v105, 0
v_pk_add_f32 v[34:35], v[34:35], 1.0 op_sel_hi:[1,0]
v_pk_add_f32 v[50:51], v[50:51], 1.0 op_sel_hi:[1,0]
v_rcp_f32 v34, v34
v_rcp_f32 v35, v35
v_rcp_f32 v50, v50
v_rcp_f32 v51, v51
s_nop 0
v_pk_fma_f32 v[100:101], v[42:43], v[34:35], v[100:101]
v_pk_fma_f32 v[104:105], v[58:59], v[50:51], v[104:105]
s_branch SL1_A5
SL1_F6:
s_add_u32 s51, s51, 1
v_readlane_b32 s52, v127, s51
v_add_f32 v112, v100, v101
v_add_f32 v113, v104, v105
v_cvt_f64_f32 v[110:111], v112
v_cvt_f64_f32 v[114:115], v113
ds_add_f64 v126, v[110:111]
ds_add_f64 v126, v[114:115] offset:256
v_add_u32 v126, 528, v126
s_sub_u32 s49, s52, s50
v_mov_b32 v100, 0
v_mov_b32 v101, 0
v_mov_b32 v104, 0
v_mov_b32 v105, 0
v_pk_add_f32 v[36:37], v[36:37], 1.0 op_sel_hi:[1,0]
v_pk_add_f32 v[52:53], v[52:53], 1.0 op_sel_hi:[1,0]
v_rcp_f32 v36, v36
v_rcp_f32 v37, v37
v_rcp_f32 v52, v52
v_rcp_f32 v53, v53
s_nop 0
v_pk_fma_f32 v[100:101], v[44:45], v[36:37], v[100:101]
v_pk_fma_f32 v[104:105], v[60:61], v[52:53], v[104:105]
s_branch SL1_A6
SL1_F7:
s_add_u32 s51, s51, 1
v_readlane_b32 s52, v127, s51
v_add_f32 v112, v100, v101
v_add_f32 v113, v104, v105
v_cvt_f64_f32 v[110:111], v112
v_cvt_f64_f32 v[114:115], v113
ds_add_f64 v126, v[110:111]
ds_add_f64 v126, v[114:115] offset:256
v_add_u32 v126, 528, v126
s_sub_u32 s49, s52, s50
v_mov_b32 v100, 0
v_mov_b32 v101, 0
v_mov_b32 v104, 0
v_mov_b32 v105, 0
v_pk_add_f32 v[38:39], v[38:39], 1.0 op_sel_hi:[1,0]
v_pk_add_f32 v[54:55], v[54:55], 1.0 op_sel_hi:[1,0]
v_rcp_f32 v38, v38
v_rcp_f32 v39, v39
v_rcp_f32 v54, v54
v_rcp_f32 v55, v55
s_nop 0
v_pk_fma_f32 v[100:101], v[46:47], v[38:39], v[100:101]
v_pk_fma_f32 v[104:105], v[62:63], v[54:55], v[104:105]
s_branch SL1_J1
.section .rodata,"a"
.p2align 6
.amdhsa_kernel standalone__mpnn_edge_mlp__graph_kernel
  .amdhsa_next_free_vgpr 128
  .amdhsa_next_free_sgpr 84
  .amdhsa_accum_offset 128
  .amdhsa_group_segment_fixed_size 0
  .amdhsa_kernarg_size 72
  .amdhsa_user_sgpr_count 2
  .amdhsa_user_sgpr_kernarg_segment_ptr 1
  .amdhsa_system_sgpr_workgroup_id_x 1
.end_amdhsa_kernel
```
